```python
import torch

def _softmax(x, axis=-1):
    return torch.softmax(x, dim=axis)
def _gelu(x):
    return torch.nn.functional.gelu(x, approximate="tanh")
def _silu(x):
    return torch.nn.functional.silu(x)
def _sigmoid(x):
    return torch.sigmoid(x)
def _layernorm(x, axis=-1, eps=1e-5):
    m = x.mean(dim=axis, keepdim=True)
    v = x.var(dim=axis, keepdim=True, unbiased=False)
    return (x - m) / torch.sqrt(v + eps)
def _scatter_add(tgt, idx, src, axis=0):
    return tgt.clone().index_add_(axis, idx, src)
def _segment_sum(src, seg, n):
    out = torch.zeros((n,) + src.shape[1:], dtype=src.dtype)
    return out.index_add_(0, seg, src)
def _pad(x, pw):
    flat = tuple(v for pair in reversed(pw) for v in pair)
    return torch.nn.functional.pad(x, flat)

kernel_name = 'standalone__gqa_softmax__near_ridge'

def setup_inputs():

    _w = (lambda a: (lambda t: t.to(torch.bfloat16) if t.is_floating_point() else t)(torch.as_tensor(a)))
    B, Hq, Hkv, Sq, Sk, D = 8, 32, 8, 160, 1024, 128
    return {
        "q": _w((lambda *s: torch.randn(*s, dtype=torch.bfloat16) * 0.8)(B, Hq, Sq, D)),
        "k": _w((lambda *s: torch.randn(*s, dtype=torch.bfloat16) * 0.8)(B, Hkv, Sk, D)),
        "v": _w((lambda *s: torch.randn(*s, dtype=torch.bfloat16) * 0.05)(B, Hkv, Sk, D)),
    }

def reference(q, k, v):
    B, Hq, Sq, D = q.shape
    Hkv = k.shape[1]
    rep = Hq // Hkv
    k = (lambda x, n, axis: torch.repeat_interleave(x, n, dim=axis))(k, rep, axis=1)
    v = (lambda x, n, axis: torch.repeat_interleave(x, n, dim=axis))(v, rep, axis=1)
    scale = D ** -0.5
    scores = torch.einsum("bhqd,bhkd->bhqk", q, k) * scale
    p = _softmax(scores, axis=-1)
    return torch.einsum("bhqk,bhkd->bhqd", p, v)
```

```asm
; @launch grid=(256,1,1) block=(256,1,1) lds=163840
.amdgcn_target "amdgcn-amd-amdhsa--gfx950"
.text
.globl standalone__gqa_softmax__near_ridge_kernel
.p2align 8
.type standalone__gqa_softmax__near_ridge_kernel,@function
standalone__gqa_softmax__near_ridge_kernel:
    s_cmp_ge_u32 s2, 256
    s_cbranch_scc1 L_end
    s_load_dwordx4 s[40:43], s[0:1], 0
    s_load_dwordx4 s[44:47], s[0:1], 16
    s_getpc_b64 s[60:61]
L_pc:
    v_lshrrev_b32 v1, 6, v0
    s_lshr_b32 s62, s2, 3
    s_lshl_b32 s62, s62, 2
    v_add_u32 v1, s62, v1
    v_and_b32 v23, 63, v1
    v_lshlrev_b32 v1, 7, v1
    s_sub_u32 s60, s60, L_pc-standalone__gqa_softmax__near_ridge_kernel
    s_subb_u32 s61, s61, 0
    global_load_dword v62, v1, s[60:61]
    global_load_dword v63, v1, s[60:61] offset:64
    v_and_b32 v1, 15, v23
    v_lshlrev_b32 v1, 7, v1
    v_add_u32 v1, 16384, v1
    global_load_dword v62, v1, s[60:61]
    global_load_dword v63, v1, s[60:61] offset:64
    v_lshlrev_b32 v23, 7, v23
    v_add_u32 v23, (L_tailcode-standalone__gqa_softmax__near_ridge_kernel)&0xffffff80, v23
    v_lshrrev_b32 v1, 6, v0
    v_and_b32 v33, 63, v0
    s_and_b32 s48, s2, 7
    s_lshr_b32 s49, s2, 3
    v_readfirstlane_b32 s20, v1
    s_lshl_b32 s54, s48, 5
    s_add_u32 s54, s54, s49
    s_mul_i32 s54, s54, 40960
    s_lshl_b32 s51, s48, 3
    s_lshr_b32 s52, s49, 2
    s_add_u32 s51, s51, s52
    s_lshl_b32 s51, s51, 18
    v_and_b32 v2, 15, v33
    v_lshrrev_b32 v3, 4, v33
    v_add_u32 v4, 0, v3
    v_lshlrev_b32 v4, 1, v4
    v_xor_b32 v4, v2, v4
    v_lshlrev_b32 v4, 4, v4
    v_lshl_add_u32 v20, v3, 8, v4
    v_add_u32 v4, 4, v3
    v_lshlrev_b32 v4, 1, v4
    v_xor_b32 v4, v2, v4
    v_lshlrev_b32 v4, 4, v4
    v_lshl_add_u32 v21, v3, 8, v4
    s_lshr_b32 s21, s20, 1
    s_and_b32 s22, s20, 1
    s_lshl_b32 s23, s20, 12
    s_mul_i32 s27, s21, 20480
    s_lshl_b32 s53, s22, 11
    s_add_u32 s27, s27, s53
    s_mov_b32 s6, 40960
    s_mov_b32 s7, 0x20000
    s_mov_b32 s10, 262144
    s_mov_b32 s11, 0x20000
    s_waitcnt lgkmcnt(0)
    s_add_u32 s4, s40, s54
    s_addc_u32 s5, s41, 0
    s_and_b32 s5, s5, 0xffff
    s_add_u32 s8, s42, s51
    s_addc_u32 s9, s43, 0
    s_and_b32 s9, s9, 0xffff
    s_add_u32 s50, s27, 0
    s_add_u32 m0, s50, 122880
    s_nop 0
    buffer_load_dwordx4 v20, s[4:7], s50 offen offset:0  lds
    buffer_load_dwordx4 v21, s[4:7], s50 offen offset:1024  lds
    s_add_u32 s24, s23, 0
    s_add_u32 m0, s23, 0
    s_nop 0
    buffer_load_dwordx4 v20, s[8:11], s24 offen offset:0  lds
    buffer_load_dwordx4 v21, s[8:11], s24 offen offset:1024  lds
    buffer_load_dwordx4 v20, s[8:11], s24 offen offset:2048  lds
    buffer_load_dwordx4 v21, s[8:11], s24 offen offset:3072  lds
    s_add_u32 s12, s44, s51
    s_addc_u32 s13, s45, 0
    s_and_b32 s13, s13, 0xffff
    s_mov_b32 s14, 262144
    s_mov_b32 s15, 0x20000
    s_add_u32 s16, s46, s54
    s_addc_u32 s17, s47, 0
    s_and_b32 s17, s17, 0xffff
    s_mov_b32 s18, 40960
    s_mov_b32 s19, 0x20000
    s_add_u32 s50, s27, 4096
    s_add_u32 m0, s50, 122880
    s_nop 0
    buffer_load_dwordx4 v20, s[4:7], s50 offen offset:0  lds
    buffer_load_dwordx4 v21, s[4:7], s50 offen offset:1024  lds
    s_add_u32 m0, s23, 65536
    s_nop 0
    buffer_load_dwordx4 v20, s[12:15], s24 offen offset:0  lds
    buffer_load_dwordx4 v21, s[12:15], s24 offen offset:1024  lds
    v_and_b32 v2, 15, v33
    v_lshrrev_b32 v3, 4, v33
    s_lshl_b32 s48, s22, 5
    v_and_b32 v4, 7, v2
    v_lshlrev_b32 v4, 1, v4
    v_add_u32 v5, s48, v2
    v_lshlrev_b32 v5, 8, v5
    v_add_u32 v6, 0, v3
    v_xor_b32 v6, v6, v4
    v_lshl_add_u32 v8, v6, 4, v5
    v_add_u32 v6, 4, v3
    v_xor_b32 v6, v6, v4
    v_lshl_add_u32 v9, v6, 4, v5
    v_add_u32 v6, 8, v3
    v_xor_b32 v6, v6, v4
    v_lshl_add_u32 v10, v6, 4, v5
    v_add_u32 v6, 12, v3
    v_xor_b32 v6, v6, v4
    v_lshl_add_u32 v11, v6, 4, v5
    v_lshrrev_b32 v4, 2, v2
    v_and_b32 v5, 1, v3
    v_lshl_add_u32 v5, v5, 2, v4
    s_lshl_b32 s49, s22, 2
    v_xor_b32 v5, s49, v5
    v_lshl_add_u32 v6, v3, 2, v4
    v_add_u32 v6, s48, v6
    v_lshlrev_b32 v6, 8, v6
    v_and_b32 v7, 3, v2
    v_lshl_add_u32 v6, v7, 3, v6
    v_add_u32 v6, 65536, v6
    v_xor_b32 v7, 0, v5
    v_lshl_add_u32 v12, v7, 5, v6
    v_xor_b32 v7, 1, v5
    v_lshl_add_u32 v13, v7, 5, v6
    v_xor_b32 v7, 2, v5
    v_lshl_add_u32 v14, v7, 5, v6
    v_xor_b32 v7, 3, v5
    v_lshl_add_u32 v15, v7, 5, v6
    v_xor_b32 v7, 4, v5
    v_lshl_add_u32 v16, v7, 5, v6
    v_xor_b32 v7, 5, v5
    v_lshl_add_u32 v17, v7, 5, v6
    v_xor_b32 v7, 6, v5
    v_lshl_add_u32 v18, v7, 5, v6
    v_xor_b32 v7, 7, v5
    v_lshl_add_u32 v19, v7, 5, v6
    v_cmp_eq_u32 vcc, 0, v2
    v_mov_b32 v4, 0x3f803f80
    s_nop 0
    v_cndmask_b32 v24, 0, v4, vcc
    v_mov_b32 v25, v24
    v_mov_b32 v26, v24
    v_mov_b32 v27, v24
    s_mul_i32 s48, s21, 20480
    s_lshl_b32 s49, s22, 13
    s_sub_u32 s48, s48, s49
    s_add_u32 s48, s48, 122880
    v_add_u32 v240, s48, v8
    v_add_u32 v241, s48, v9
    v_add_u32 v242, s48, v10
    v_add_u32 v243, s48, v11
    s_mov_b32 s56, 0x3e0293ee
    s_mov_b32 s57, 0x3e0293ee
    s_mov_b32 s58, 0xffff0000
    s_mul_i32 s48, s20, 20480
    s_xor_b32 s49, s20, 1
    s_mul_i32 s50, s49, 20480
    v_lshlrev_b32 v2, 4, v33
    v_add_u32 v35, s50, v2
    v_add_u32 v34, s48, v2
    s_mul_i32 s48, s21, 2560
    s_add_u32 s48, s48, 81920
    s_lshl_b32 s50, s22, 4
    v_and_b32 v4, 15, v33
    v_lshlrev_b32 v5, 5, v4
    v_add_u32 v5, s48, v5
    v_lshrrev_b32 v6, 3, v4
    v_lshl_add_u32 v61, v6, 4, v5
    v_xor_b32 v6, 1, v6
    v_lshl_add_u32 v22, v6, 4, v5
    s_lshl_b32 s50, s22, 2
    v_lshrrev_b32 v6, 2, v4
    v_lshlrev_b32 v6, 1, v6
    v_lshrrev_b32 v7, 4, v33
    v_add_u32 v6, v6, v7
    v_add_u32 v6, s50, v6
    v_and_b32 v6, 7, v6
    v_lshl_add_u32 v60, v6, 2, v5
    v_and_b32 v6, 15, v33
    v_lshrrev_b32 v7, 4, v33
    s_mul_i32 s48, s20, 10240
    s_add_u32 s48, s48, 98304
    v_lshlrev_b32 v1, 7, v6
    v_add_u32 v1, s48, v1
    v_lshrrev_b32 v2, 3, v6
    v_xor_b32 v2, v2, v7
    v_and_b32 v2, 1, v2
    v_lshl_add_u32 v1, v2, 3, v1
    v_lshrrev_b32 v2, 1, v7
    v_and_b32 v3, 7, v6
    v_xor_b32 v2, v2, v3
    v_xor_b32 v3, 0, v2
    v_lshl_add_u32 v244, v3, 4, v1
    v_xor_b32 v3, 2, v2
    v_lshl_add_u32 v245, v3, 4, v1
    v_xor_b32 v3, 4, v2
    v_lshl_add_u32 v246, v3, 4, v1
    v_xor_b32 v3, 6, v2
    v_lshl_add_u32 v247, v3, 4, v1
    v_lshrrev_b32 v6, 3, v33
    v_and_b32 v7, 7, v33
    v_xor_b32 v1, v6, v7
    v_lshlrev_b32 v1, 4, v1
    v_lshl_add_u32 v1, v6, 7, v1
    v_add_u32 v248, s48, v1
    s_mul_i32 s49, s21, 20480
    s_lshl_b32 s50, s22, 7
    s_add_u32 s49, s49, s50
    v_lshlrev_b32 v7, 4, v7
    v_lshl_add_u32 v7, v6, 8, v7
    v_add_u32 v249, s49, v7
    s_waitcnt vmcnt(9)
    buffer_load_dwordx4 v20, s[12:15], s24 offen offset:2048  lds
    s_waitcnt vmcnt(9)
    buffer_load_dwordx4 v21, s[12:15], s24 offen offset:3072  lds
    s_waitcnt vmcnt(10)
    s_barrier
    ds_read_b128 v[64:67], v240 offset:0
    ds_read_b128 v[68:71], v241 offset:0
    ds_read_b128 v[72:75], v242 offset:0
    ds_read_b128 v[76:79], v243 offset:0
    s_waitcnt lgkmcnt(0)
    v_lshlrev_b32 v224, 16, v64
    v_and_b32 v225, s58, v64
    v_lshlrev_b32 v226, 16, v65
    v_and_b32 v227, s58, v65
    v_lshlrev_b32 v228, 16, v66
    v_and_b32 v229, s58, v66
    v_lshlrev_b32 v230, 16, v67
    v_and_b32 v231, s58, v67
    v_pk_mul_f32 v[224:225], v[224:225], s[56:57]
    v_pk_mul_f32 v[226:227], v[226:227], s[56:57]
    v_pk_mul_f32 v[228:229], v[228:229], s[56:57]
    v_pk_mul_f32 v[230:231], v[230:231], s[56:57]
    v_cvt_pk_bf16_f32 v64, v224, v225
    v_cvt_pk_bf16_f32 v65, v226, v227
    v_cvt_pk_bf16_f32 v66, v228, v229
    v_cvt_pk_bf16_f32 v67, v230, v231
    v_lshlrev_b32 v224, 16, v68
    v_and_b32 v225, s58, v68
    v_lshlrev_b32 v226, 16, v69
    v_and_b32 v227, s58, v69
    v_lshlrev_b32 v228, 16, v70
    v_and_b32 v229, s58, v70
    v_lshlrev_b32 v230, 16, v71
    v_and_b32 v231, s58, v71
    v_pk_mul_f32 v[224:225], v[224:225], s[56:57]
    v_pk_mul_f32 v[226:227], v[226:227], s[56:57]
    v_pk_mul_f32 v[228:229], v[228:229], s[56:57]
    v_pk_mul_f32 v[230:231], v[230:231], s[56:57]
    v_cvt_pk_bf16_f32 v68, v224, v225
    v_cvt_pk_bf16_f32 v69, v226, v227
    v_cvt_pk_bf16_f32 v70, v228, v229
    v_cvt_pk_bf16_f32 v71, v230, v231
    v_lshlrev_b32 v224, 16, v72
    v_and_b32 v225, s58, v72
    v_lshlrev_b32 v226, 16, v73
    v_and_b32 v227, s58, v73
    v_lshlrev_b32 v228, 16, v74
    v_and_b32 v229, s58, v74
    v_lshlrev_b32 v230, 16, v75
    v_and_b32 v231, s58, v75
    v_pk_mul_f32 v[224:225], v[224:225], s[56:57]
    v_pk_mul_f32 v[226:227], v[226:227], s[56:57]
    v_pk_mul_f32 v[228:229], v[228:229], s[56:57]
    v_pk_mul_f32 v[230:231], v[230:231], s[56:57]
    v_cvt_pk_bf16_f32 v72, v224, v225
    v_cvt_pk_bf16_f32 v73, v226, v227
    v_cvt_pk_bf16_f32 v74, v228, v229
    v_cvt_pk_bf16_f32 v75, v230, v231
    v_lshlrev_b32 v224, 16, v76
    v_and_b32 v225, s58, v76
    v_lshlrev_b32 v226, 16, v77
    v_and_b32 v227, s58, v77
    v_lshlrev_b32 v228, 16, v78
    v_and_b32 v229, s58, v78
    v_lshlrev_b32 v230, 16, v79
    v_and_b32 v231, s58, v79
    v_pk_mul_f32 v[224:225], v[224:225], s[56:57]
    v_pk_mul_f32 v[226:227], v[226:227], s[56:57]
    v_pk_mul_f32 v[228:229], v[228:229], s[56:57]
    v_pk_mul_f32 v[230:231], v[230:231], s[56:57]
    v_cvt_pk_bf16_f32 v76, v224, v225
    v_cvt_pk_bf16_f32 v77, v226, v227
    v_cvt_pk_bf16_f32 v78, v228, v229
    v_cvt_pk_bf16_f32 v79, v230, v231
    s_waitcnt vmcnt(9)
    s_add_u32 s50, s27, 8192
    s_add_u32 m0, s50, 122880
    s_nop 0
    buffer_load_dwordx4 v20, s[4:7], s50 offen offset:0  lds
    s_waitcnt vmcnt(9)
    buffer_load_dwordx4 v21, s[4:7], s50 offen offset:1024  lds
    s_waitcnt vmcnt(9)
    s_add_u32 s24, s24, 16384
    s_add_u32 m0, s23, 16384
    s_nop 0
    buffer_load_dwordx4 v20, s[8:11], s24 offen offset:0  lds
    s_waitcnt vmcnt(9)
    buffer_load_dwordx4 v21, s[8:11], s24 offen offset:1024  lds
    s_waitcnt vmcnt(10)
    s_barrier
    ds_read_b128 a[80:83], v8 offset:0
    ds_read_b128 a[84:87], v9 offset:0
    ds_read_b128 a[88:91], v10 offset:0
    ds_read_b128 a[92:95], v11 offset:0
    ds_read_b128 a[96:99], v8 offset:4096
    ds_read_b128 a[100:103], v9 offset:4096
    ds_read_b128 a[104:107], v10 offset:4096
    ds_read_b128 a[108:111], v11 offset:4096
    buffer_load_dwordx4 v20, s[8:11], s24 offen offset:2048  lds
    buffer_load_dwordx4 v21, s[8:11], s24 offen offset:3072  lds
    s_waitcnt lgkmcnt(0)
    s_nop 0
    v_mfma_f32_16x16x32_bf16 v[36:39], a[80:83], v[64:67], 0
    v_mfma_f32_16x16x32_bf16 v[36:39], a[84:87], v[68:71], v[36:39]
    v_mfma_f32_16x16x32_bf16 v[36:39], a[88:91], v[72:75], v[36:39]
    v_mfma_f32_16x16x32_bf16 v[36:39], a[92:95], v[76:79], v[36:39]
    v_mfma_f32_16x16x32_bf16 v[40:43], a[96:99], v[64:67], 0
    v_mfma_f32_16x16x32_bf16 v[40:43], a[100:103], v[68:71], v[40:43]
    v_mfma_f32_16x16x32_bf16 v[40:43], a[104:107], v[72:75], v[40:43]
    v_mfma_f32_16x16x32_bf16 v[40:43], a[108:111], v[76:79], v[40:43]
    s_waitcnt vmcnt(10)
    s_barrier
    ds_read_b128 v[80:83], v240 offset:4096
    ds_read_b128 v[84:87], v241 offset:4096
    ds_read_b128 v[88:91], v242 offset:4096
    ds_read_b128 v[92:95], v243 offset:4096
    s_add_u32 s50, s27, 12288
    s_add_u32 m0, s50, 122880
    s_nop 0
    buffer_load_dwordx4 v20, s[4:7], s50 offen offset:0  lds
    s_waitcnt lgkmcnt(0)
    v_lshlrev_b32 v224, 16, v80
    v_and_b32 v225, s58, v80
    v_lshlrev_b32 v226, 16, v81
    v_and_b32 v227, s58, v81
    v_lshlrev_b32 v228, 16, v82
    v_and_b32 v229, s58, v82
    v_lshlrev_b32 v230, 16, v83
    v_and_b32 v231, s58, v83
    v_pk_mul_f32 v[224:225], v[224:225], s[56:57]
    v_pk_mul_f32 v[226:227], v[226:227], s[56:57]
    v_pk_mul_f32 v[228:229], v[228:229], s[56:57]
    v_pk_mul_f32 v[230:231], v[230:231], s[56:57]
    v_cvt_pk_bf16_f32 v80, v224, v225
    v_cvt_pk_bf16_f32 v81, v226, v227
    v_cvt_pk_bf16_f32 v82, v228, v229
    v_cvt_pk_bf16_f32 v83, v230, v231
    v_lshlrev_b32 v224, 16, v84
    v_and_b32 v225, s58, v84
    v_lshlrev_b32 v226, 16, v85
    v_and_b32 v227, s58, v85
    v_lshlrev_b32 v228, 16, v86
    v_and_b32 v229, s58, v86
    v_lshlrev_b32 v230, 16, v87
    v_and_b32 v231, s58, v87
    v_pk_mul_f32 v[224:225], v[224:225], s[56:57]
    v_pk_mul_f32 v[226:227], v[226:227], s[56:57]
    v_pk_mul_f32 v[228:229], v[228:229], s[56:57]
    v_pk_mul_f32 v[230:231], v[230:231], s[56:57]
    v_cvt_pk_bf16_f32 v84, v224, v225
    v_cvt_pk_bf16_f32 v85, v226, v227
    v_cvt_pk_bf16_f32 v86, v228, v229
    v_cvt_pk_bf16_f32 v87, v230, v231
    buffer_load_dwordx4 v21, s[4:7], s50 offen offset:1024  lds
    v_lshlrev_b32 v224, 16, v88
    v_and_b32 v225, s58, v88
    v_lshlrev_b32 v226, 16, v89
    v_and_b32 v227, s58, v89
    v_lshlrev_b32 v228, 16, v90
    v_and_b32 v229, s58, v90
    v_lshlrev_b32 v230, 16, v91
    v_and_b32 v231, s58, v91
    v_pk_mul_f32 v[224:225], v[224:225], s[56:57]
    v_pk_mul_f32 v[226:227], v[226:227], s[56:57]
    v_pk_mul_f32 v[228:229], v[228:229], s[56:57]
    v_pk_mul_f32 v[230:231], v[230:231], s[56:57]
    v_cvt_pk_bf16_f32 v88, v224, v225
    v_cvt_pk_bf16_f32 v89, v226, v227
    v_cvt_pk_bf16_f32 v90, v228, v229
    v_cvt_pk_bf16_f32 v91, v230, v231
    v_lshlrev_b32 v224, 16, v92
    v_and_b32 v225, s58, v92
    v_lshlrev_b32 v226, 16, v93
    v_and_b32 v227, s58, v93
    v_lshlrev_b32 v228, 16, v94
    v_and_b32 v229, s58, v94
    v_lshlrev_b32 v230, 16, v95
    v_and_b32 v231, s58, v95
    v_pk_mul_f32 v[224:225], v[224:225], s[56:57]
    v_pk_mul_f32 v[226:227], v[226:227], s[56:57]
    v_pk_mul_f32 v[228:229], v[228:229], s[56:57]
    v_pk_mul_f32 v[230:231], v[230:231], s[56:57]
    v_cvt_pk_bf16_f32 v92, v224, v225
    v_cvt_pk_bf16_f32 v93, v226, v227
    v_cvt_pk_bf16_f32 v94, v228, v229
    v_cvt_pk_bf16_f32 v95, v230, v231
    s_nop 1
    v_mfma_f32_16x16x32_bf16 v[44:47], a[80:83], v[80:83], 0
    v_exp_f32 v36, v36
    v_mfma_f32_16x16x32_bf16 v[44:47], a[84:87], v[84:87], v[44:47]
    v_mfma_f32_16x16x32_bf16 v[44:47], a[88:91], v[88:91], v[44:47]
    v_exp_f32 v37, v37
    v_mfma_f32_16x16x32_bf16 v[44:47], a[92:95], v[92:95], v[44:47]
    v_mov_b32 v28, v36
    v_add_f32 v28, v28, v37
    v_mfma_f32_16x16x32_bf16 v[48:51], a[96:99], v[80:83], 0
    v_exp_f32 v38, v38
    v_mfma_f32_16x16x32_bf16 v[48:51], a[100:103], v[84:87], v[48:51]
    v_cvt_pk_bf16_f32 v52, v36, v37
    v_add_f32 v28, v28, v38
    v_mfma_f32_16x16x32_bf16 v[48:51], a[104:107], v[88:91], v[48:51]
    v_exp_f32 v39, v39
    v_mfma_f32_16x16x32_bf16 v[48:51], a[108:111], v[92:95], v[48:51]
    v_add_f32 v28, v28, v39
    v_cvt_pk_bf16_f32 v53, v38, v39
    s_nop 0
    v_exp_f32 v40, v40
    s_nop 0
    s_nop 0
    v_exp_f32 v41, v41
    s_nop 0
    v_add_f32 v28, v28, v40
    v_add_f32 v28, v28, v41
    s_nop 0
    v_exp_f32 v42, v42
    s_nop 0
    v_cvt_pk_bf16_f32 v54, v40, v41
    v_add_f32 v28, v28, v42
    s_nop 0
    v_exp_f32 v43, v43
    s_nop 0
    v_add_f32 v28, v28, v43
    v_cvt_pk_bf16_f32 v55, v42, v43
    s_waitcnt vmcnt(9)
    s_add_u32 m0, s23, 81920
    s_nop 0
    buffer_load_dwordx4 v20, s[12:15], s24 offen offset:0  lds
    s_waitcnt vmcnt(9)
    buffer_load_dwordx4 v21, s[12:15], s24 offen offset:1024  lds
    s_waitcnt vmcnt(9)
    buffer_load_dwordx4 v20, s[12:15], s24 offen offset:2048  lds
    s_waitcnt vmcnt(9)
    buffer_load_dwordx4 v21, s[12:15], s24 offen offset:3072  lds
    s_waitcnt vmcnt(10)
    s_barrier
    ds_read_b128 v[96:99], v240 offset:8192
    ds_read_b128 v[100:103], v241 offset:8192
    ds_read_b128 v[104:107], v242 offset:8192
    ds_read_b128 v[108:111], v243 offset:8192
    ds_read_b64_tr_b16 a[144:145], v12 offset:0
    ds_read_b64_tr_b16 a[146:147], v12 offset:4096
    ds_read_b64_tr_b16 a[148:149], v13 offset:0
    ds_read_b64_tr_b16 a[150:151], v13 offset:4096
    ds_read_b64_tr_b16 a[152:153], v14 offset:0
    ds_read_b64_tr_b16 a[154:155], v14 offset:4096
    ds_read_b64_tr_b16 a[156:157], v15 offset:0
    ds_read_b64_tr_b16 a[158:159], v15 offset:4096
    ds_read_b64_tr_b16 a[160:161], v16 offset:0
    ds_read_b64_tr_b16 a[162:163], v16 offset:4096
    ds_read_b64_tr_b16 a[164:165], v17 offset:0
    ds_read_b64_tr_b16 a[166:167], v17 offset:4096
    ds_read_b64_tr_b16 a[168:169], v18 offset:0
    ds_read_b64_tr_b16 a[170:171], v18 offset:4096
    ds_read_b64_tr_b16 a[172:173], v19 offset:0
    ds_read_b64_tr_b16 a[174:175], v19 offset:4096
    s_add_u32 s50, s27, 16384
    s_add_u32 m0, s50, 122880
    s_nop 0
    buffer_load_dwordx4 v20, s[4:7], s50 offen offset:0  lds
    s_waitcnt lgkmcnt(15)
    v_lshlrev_b32 v224, 16, v96
    v_and_b32 v225, s58, v96
    v_lshlrev_b32 v226, 16, v97
    v_and_b32 v227, s58, v97
    v_lshlrev_b32 v228, 16, v98
    v_and_b32 v229, s58, v98
    v_lshlrev_b32 v230, 16, v99
    v_and_b32 v231, s58, v99
    v_pk_mul_f32 v[224:225], v[224:225], s[56:57]
    v_pk_mul_f32 v[226:227], v[226:227], s[56:57]
    v_pk_mul_f32 v[228:229], v[228:229], s[56:57]
    v_pk_mul_f32 v[230:231], v[230:231], s[56:57]
    v_cvt_pk_bf16_f32 v96, v224, v225
    v_cvt_pk_bf16_f32 v97, v226, v227
    v_cvt_pk_bf16_f32 v98, v228, v229
    v_cvt_pk_bf16_f32 v99, v230, v231
    v_lshlrev_b32 v224, 16, v100
    v_and_b32 v225, s58, v100
    v_lshlrev_b32 v226, 16, v101
    v_and_b32 v227, s58, v101
    v_lshlrev_b32 v228, 16, v102
    v_and_b32 v229, s58, v102
    v_lshlrev_b32 v230, 16, v103
    v_and_b32 v231, s58, v103
    v_pk_mul_f32 v[224:225], v[224:225], s[56:57]
    v_pk_mul_f32 v[226:227], v[226:227], s[56:57]
    v_pk_mul_f32 v[228:229], v[228:229], s[56:57]
    v_pk_mul_f32 v[230:231], v[230:231], s[56:57]
    v_cvt_pk_bf16_f32 v100, v224, v225
    v_cvt_pk_bf16_f32 v101, v226, v227
    v_cvt_pk_bf16_f32 v102, v228, v229
    v_cvt_pk_bf16_f32 v103, v230, v231
    buffer_load_dwordx4 v21, s[4:7], s50 offen offset:1024  lds
    v_lshlrev_b32 v224, 16, v104
    v_and_b32 v225, s58, v104
    v_lshlrev_b32 v226, 16, v105
    v_and_b32 v227, s58, v105
    v_lshlrev_b32 v228, 16, v106
    v_and_b32 v229, s58, v106
    v_lshlrev_b32 v230, 16, v107
    v_and_b32 v231, s58, v107
    v_pk_mul_f32 v[224:225], v[224:225], s[56:57]
    v_pk_mul_f32 v[226:227], v[226:227], s[56:57]
    v_pk_mul_f32 v[228:229], v[228:229], s[56:57]
    v_pk_mul_f32 v[230:231], v[230:231], s[56:57]
    v_cvt_pk_bf16_f32 v104, v224, v225
    v_cvt_pk_bf16_f32 v105, v226, v227
    v_cvt_pk_bf16_f32 v106, v228, v229
    v_cvt_pk_bf16_f32 v107, v230, v231
    v_lshlrev_b32 v224, 16, v108
    v_and_b32 v225, s58, v108
    v_lshlrev_b32 v226, 16, v109
    v_and_b32 v227, s58, v109
    v_lshlrev_b32 v228, 16, v110
    v_and_b32 v229, s58, v110
    v_lshlrev_b32 v230, 16, v111
    v_and_b32 v231, s58, v111
    v_pk_mul_f32 v[224:225], v[224:225], s[56:57]
    v_pk_mul_f32 v[226:227], v[226:227], s[56:57]
    v_pk_mul_f32 v[228:229], v[228:229], s[56:57]
    v_pk_mul_f32 v[230:231], v[230:231], s[56:57]
    v_cvt_pk_bf16_f32 v108, v224, v225
    v_cvt_pk_bf16_f32 v109, v226, v227
    v_cvt_pk_bf16_f32 v110, v228, v229
    v_cvt_pk_bf16_f32 v111, v230, v231
    s_waitcnt lgkmcnt(0)
    s_nop 1
    v_mfma_f32_16x16x32_bf16 v[36:39], a[80:83], v[96:99], 0
    v_exp_f32 v44, v44
    v_mfma_f32_16x16x32_bf16 v[36:39], a[84:87], v[100:103], v[36:39]
    v_mfma_f32_16x16x32_bf16 v[36:39], a[88:91], v[104:107], v[36:39]
    v_exp_f32 v45, v45
    v_mfma_f32_16x16x32_bf16 v[36:39], a[92:95], v[108:111], v[36:39]
    v_mov_b32 v29, v44
    v_add_f32 v29, v29, v45
    v_mfma_f32_16x16x32_bf16 v[40:43], a[96:99], v[96:99], 0
    v_exp_f32 v46, v46
    v_mfma_f32_16x16x32_bf16 v[40:43], a[100:103], v[100:103], v[40:43]
    v_cvt_pk_bf16_f32 v56, v44, v45
    v_add_f32 v29, v29, v46
    v_mfma_f32_16x16x32_bf16 v[40:43], a[104:107], v[104:107], v[40:43]
    v_exp_f32 v47, v47
    v_mfma_f32_16x16x32_bf16 v[40:43], a[108:111], v[108:111], v[40:43]
    v_add_f32 v29, v29, v47
    v_cvt_pk_bf16_f32 v57, v46, v47
    v_mfma_f32_16x16x32_bf16 v[144:147], a[144:147], v[52:55], 0
    v_exp_f32 v48, v48
    v_mfma_f32_16x16x32_bf16 v[148:151], a[148:151], v[52:55], 0
    v_mfma_f32_16x16x32_bf16 v[152:155], a[152:155], v[52:55], 0
    v_exp_f32 v49, v49
    v_mfma_f32_16x16x32_bf16 v[156:159], a[156:159], v[52:55], 0
    v_add_f32 v29, v29, v48
    v_add_f32 v29, v29, v49
    v_mfma_f32_16x16x32_bf16 a[0:3], a[160:163], v[52:55], 0
    v_exp_f32 v50, v50
    v_mfma_f32_16x16x32_bf16 a[4:7], a[164:167], v[52:55], 0
    v_cvt_pk_bf16_f32 v58, v48, v49
    v_add_f32 v29, v29, v50
    v_mfma_f32_16x16x32_bf16 a[8:11], a[168:171], v[52:55], 0
    v_exp_f32 v51, v51
    v_mfma_f32_16x16x32_bf16 a[12:15], a[172:175], v[52:55], 0
    v_add_f32 v29, v29, v51
    v_cvt_pk_bf16_f32 v59, v50, v51
    s_waitcnt vmcnt(9)
    s_add_u32 s24, s24, 16384
    s_add_u32 m0, s23, 32768
    s_nop 0
    buffer_load_dwordx4 v20, s[8:11], s24 offen offset:0  lds
    s_waitcnt vmcnt(9)
    buffer_load_dwordx4 v21, s[8:11], s24 offen offset:1024  lds
    s_waitcnt vmcnt(9)
    buffer_load_dwordx4 v20, s[8:11], s24 offen offset:2048  lds
    s_waitcnt vmcnt(9)
    buffer_load_dwordx4 v21, s[8:11], s24 offen offset:3072  lds
    s_waitcnt vmcnt(10)
    s_barrier
    ds_read_b128 v[112:115], v240 offset:12288
    ds_read_b128 v[116:119], v241 offset:12288
    ds_read_b128 v[120:123], v242 offset:12288
    ds_read_b128 v[124:127], v243 offset:12288
    ds_read_b128 a[112:115], v8 offset:16384
    ds_read_b128 a[116:119], v9 offset:16384
    ds_read_b128 a[120:123], v10 offset:16384
    ds_read_b128 a[124:127], v11 offset:16384
    ds_read_b128 a[128:131], v8 offset:20480
    ds_read_b128 a[132:135], v9 offset:20480
    ds_read_b128 a[136:139], v10 offset:20480
    ds_read_b128 a[140:143], v11 offset:20480
    s_add_u32 m0, s23, 98304
    s_nop 0
    buffer_load_dwordx4 v20, s[12:15], s24 offen offset:0  lds
    s_waitcnt lgkmcnt(8)
    v_lshlrev_b32 v224, 16, v112
    v_and_b32 v225, s58, v112
    v_lshlrev_b32 v226, 16, v113
    v_and_b32 v227, s58, v113
    v_lshlrev_b32 v228, 16, v114
    v_and_b32 v229, s58, v114
    v_lshlrev_b32 v230, 16, v115
    v_and_b32 v231, s58, v115
    v_pk_mul_f32 v[224:225], v[224:225], s[56:57]
    v_pk_mul_f32 v[226:227], v[226:227], s[56:57]
    v_pk_mul_f32 v[228:229], v[228:229], s[56:57]
    v_pk_mul_f32 v[230:231], v[230:231], s[56:57]
    v_cvt_pk_bf16_f32 v112, v224, v225
    v_cvt_pk_bf16_f32 v113, v226, v227
    v_cvt_pk_bf16_f32 v114, v228, v229
    v_cvt_pk_bf16_f32 v115, v230, v231
    v_lshlrev_b32 v224, 16, v116
    v_and_b32 v225, s58, v116
    v_lshlrev_b32 v226, 16, v117
    v_and_b32 v227, s58, v117
    v_lshlrev_b32 v228, 16, v118
    v_and_b32 v229, s58, v118
    v_lshlrev_b32 v230, 16, v119
    v_and_b32 v231, s58, v119
    v_pk_mul_f32 v[224:225], v[224:225], s[56:57]
    v_pk_mul_f32 v[226:227], v[226:227], s[56:57]
    v_pk_mul_f32 v[228:229], v[228:229], s[56:57]
    v_pk_mul_f32 v[230:231], v[230:231], s[56:57]
    v_cvt_pk_bf16_f32 v116, v224, v225
    v_cvt_pk_bf16_f32 v117, v226, v227
    v_cvt_pk_bf16_f32 v118, v228, v229
    v_cvt_pk_bf16_f32 v119, v230, v231
    buffer_load_dwordx4 v21, s[12:15], s24 offen offset:1024  lds
    v_lshlrev_b32 v224, 16, v120
    v_and_b32 v225, s58, v120
    v_lshlrev_b32 v226, 16, v121
    v_and_b32 v227, s58, v121
    v_lshlrev_b32 v228, 16, v122
    v_and_b32 v229, s58, v122
    v_lshlrev_b32 v230, 16, v123
    v_and_b32 v231, s58, v123
    v_pk_mul_f32 v[224:225], v[224:225], s[56:57]
    v_pk_mul_f32 v[226:227], v[226:227], s[56:57]
    v_pk_mul_f32 v[228:229], v[228:229], s[56:57]
    v_pk_mul_f32 v[230:231], v[230:231], s[56:57]
    v_cvt_pk_bf16_f32 v120, v224, v225
    v_cvt_pk_bf16_f32 v121, v226, v227
    v_cvt_pk_bf16_f32 v122, v228, v229
    v_cvt_pk_bf16_f32 v123, v230, v231
    v_lshlrev_b32 v224, 16, v124
    v_and_b32 v225, s58, v124
    v_lshlrev_b32 v226, 16, v125
    v_and_b32 v227, s58, v125
    v_lshlrev_b32 v228, 16, v126
    v_and_b32 v229, s58, v126
    v_lshlrev_b32 v230, 16, v127
    v_and_b32 v231, s58, v127
    v_pk_mul_f32 v[224:225], v[224:225], s[56:57]
    v_pk_mul_f32 v[226:227], v[226:227], s[56:57]
    v_pk_mul_f32 v[228:229], v[228:229], s[56:57]
    v_pk_mul_f32 v[230:231], v[230:231], s[56:57]
    v_cvt_pk_bf16_f32 v124, v224, v225
    v_cvt_pk_bf16_f32 v125, v226, v227
    v_cvt_pk_bf16_f32 v126, v228, v229
    v_cvt_pk_bf16_f32 v127, v230, v231
    s_nop 1
    v_mfma_f32_16x16x32_bf16 v[44:47], a[80:83], v[112:115], 0
    v_exp_f32 v36, v36
    v_mfma_f32_16x16x32_bf16 v[44:47], a[84:87], v[116:119], v[44:47]
    v_mfma_f32_16x16x32_bf16 v[44:47], a[88:91], v[120:123], v[44:47]
    v_exp_f32 v37, v37
    v_mfma_f32_16x16x32_bf16 v[44:47], a[92:95], v[124:127], v[44:47]
    v_cvt_pk_bf16_f32 v52, v36, v37
    v_mfma_f32_16x16x32_bf16 v[48:51], a[96:99], v[112:115], 0
    v_exp_f32 v38, v38
    v_mfma_f32_16x16x32_bf16 v[48:51], a[100:103], v[116:119], v[48:51]
    v_mfma_f32_16x16x32_bf16 v[48:51], a[104:107], v[120:123], v[48:51]
    v_exp_f32 v39, v39
    v_mfma_f32_16x16x32_bf16 v[48:51], a[108:111], v[124:127], v[48:51]
    v_cvt_pk_bf16_f32 v53, v38, v39
    v_mfma_f32_16x16x32_bf16 v[160:163], a[144:147], v[56:59], 0
    v_exp_f32 v40, v40
    v_mfma_f32_16x16x32_bf16 v[164:167], a[148:151], v[56:59], 0
    v_mfma_f32_16x16x32_bf16 v[168:171], a[152:155], v[56:59], 0
    v_exp_f32 v41, v41
    v_mfma_f32_16x16x32_bf16 v[172:175], a[156:159], v[56:59], 0
    v_cvt_pk_bf16_f32 v54, v40, v41
    v_mfma_f32_16x16x32_bf16 a[16:19], a[160:163], v[56:59], 0
    v_exp_f32 v42, v42
    v_mfma_f32_16x16x32_bf16 a[20:23], a[164:167], v[56:59], 0
    v_mfma_f32_16x16x32_bf16 a[24:27], a[168:171], v[56:59], 0
    v_exp_f32 v43, v43
    v_mfma_f32_16x16x32_bf16 a[28:31], a[172:175], v[56:59], 0
    v_cvt_pk_bf16_f32 v55, v42, v43
    s_waitcnt vmcnt(9)
    buffer_load_dwordx4 v20, s[12:15], s24 offen offset:2048  lds
    s_waitcnt vmcnt(9)
    buffer_load_dwordx4 v21, s[12:15], s24 offen offset:3072  lds
    s_waitcnt vmcnt(9)
    s_add_u32 s24, s24, 16384
    s_add_u32 m0, s23, 49152
    s_nop 0
    buffer_load_dwordx4 v20, s[8:11], s24 offen offset:0  lds
    s_waitcnt vmcnt(9)
    buffer_load_dwordx4 v21, s[8:11], s24 offen offset:1024  lds
    s_waitcnt vmcnt(10)
    s_barrier
    ds_read_b128 v[128:131], v240 offset:16384
    ds_read_b128 v[132:135], v241 offset:16384
    ds_read_b128 v[136:139], v242 offset:16384
    ds_read_b128 v[140:143], v243 offset:16384
    ds_read_b64_tr_b16 a[176:177], v12 offset:16384
    ds_read_b64_tr_b16 a[178:179], v12 offset:20480
    ds_read_b64_tr_b16 a[180:181], v13 offset:16384
    ds_read_b64_tr_b16 a[182:183], v13 offset:20480
    ds_read_b64_tr_b16 a[184:185], v14 offset:16384
    ds_read_b64_tr_b16 a[186:187], v14 offset:20480
    ds_read_b64_tr_b16 a[188:189], v15 offset:16384
    ds_read_b64_tr_b16 a[190:191], v15 offset:20480
    ds_read_b64_tr_b16 a[192:193], v16 offset:16384
    ds_read_b64_tr_b16 a[194:195], v16 offset:20480
    ds_read_b64_tr_b16 a[196:197], v17 offset:16384
    ds_read_b64_tr_b16 a[198:199], v17 offset:20480
    ds_read_b64_tr_b16 a[200:201], v18 offset:16384
    ds_read_b64_tr_b16 a[202:203], v18 offset:20480
    ds_read_b64_tr_b16 a[204:205], v19 offset:16384
    ds_read_b64_tr_b16 a[206:207], v19 offset:20480
    buffer_load_dwordx4 v20, s[8:11], s24 offen offset:2048  lds
    s_waitcnt lgkmcnt(15)
    v_lshlrev_b32 v224, 16, v128
    v_and_b32 v225, s58, v128
    v_lshlrev_b32 v226, 16, v129
    v_and_b32 v227, s58, v129
    v_lshlrev_b32 v228, 16, v130
    v_and_b32 v229, s58, v130
    v_lshlrev_b32 v230, 16, v131
    v_and_b32 v231, s58, v131
    v_pk_mul_f32 v[224:225], v[224:225], s[56:57]
    v_pk_mul_f32 v[226:227], v[226:227], s[56:57]
    v_pk_mul_f32 v[228:229], v[228:229], s[56:57]
    v_pk_mul_f32 v[230:231], v[230:231], s[56:57]
    v_cvt_pk_bf16_f32 v128, v224, v225
    v_cvt_pk_bf16_f32 v129, v226, v227
    v_cvt_pk_bf16_f32 v130, v228, v229
    v_cvt_pk_bf16_f32 v131, v230, v231
    v_lshlrev_b32 v224, 16, v132
    v_and_b32 v225, s58, v132
    v_lshlrev_b32 v226, 16, v133
    v_and_b32 v227, s58, v133
    v_lshlrev_b32 v228, 16, v134
    v_and_b32 v229, s58, v134
    v_lshlrev_b32 v230, 16, v135
    v_and_b32 v231, s58, v135
    v_pk_mul_f32 v[224:225], v[224:225], s[56:57]
    v_pk_mul_f32 v[226:227], v[226:227], s[56:57]
    v_pk_mul_f32 v[228:229], v[228:229], s[56:57]
    v_pk_mul_f32 v[230:231], v[230:231], s[56:57]
    v_cvt_pk_bf16_f32 v132, v224, v225
    v_cvt_pk_bf16_f32 v133, v226, v227
    v_cvt_pk_bf16_f32 v134, v228, v229
    v_cvt_pk_bf16_f32 v135, v230, v231
    buffer_load_dwordx4 v21, s[8:11], s24 offen offset:3072  lds
    v_lshlrev_b32 v224, 16, v136
    v_and_b32 v225, s58, v136
    v_lshlrev_b32 v226, 16, v137
    v_and_b32 v227, s58, v137
    v_lshlrev_b32 v228, 16, v138
    v_and_b32 v229, s58, v138
    v_lshlrev_b32 v230, 16, v139
    v_and_b32 v231, s58, v139
    v_pk_mul_f32 v[224:225], v[224:225], s[56:57]
    v_pk_mul_f32 v[226:227], v[226:227], s[56:57]
    v_pk_mul_f32 v[228:229], v[228:229], s[56:57]
    v_pk_mul_f32 v[230:231], v[230:231], s[56:57]
    v_cvt_pk_bf16_f32 v136, v224, v225
    v_cvt_pk_bf16_f32 v137, v226, v227
    v_cvt_pk_bf16_f32 v138, v228, v229
    v_cvt_pk_bf16_f32 v139, v230, v231
    v_lshlrev_b32 v224, 16, v140
    v_and_b32 v225, s58, v140
    v_lshlrev_b32 v226, 16, v141
    v_and_b32 v227, s58, v141
    v_lshlrev_b32 v228, 16, v142
    v_and_b32 v229, s58, v142
    v_lshlrev_b32 v230, 16, v143
    v_and_b32 v231, s58, v143
    v_pk_mul_f32 v[224:225], v[224:225], s[56:57]
    v_pk_mul_f32 v[226:227], v[226:227], s[56:57]
    v_pk_mul_f32 v[228:229], v[228:229], s[56:57]
    v_pk_mul_f32 v[230:231], v[230:231], s[56:57]
    v_cvt_pk_bf16_f32 v140, v224, v225
    v_cvt_pk_bf16_f32 v141, v226, v227
    v_cvt_pk_bf16_f32 v142, v228, v229
    v_cvt_pk_bf16_f32 v143, v230, v231
    s_nop 1
    v_mfma_f32_16x16x32_bf16 v[36:39], a[80:83], v[128:131], 0
    v_exp_f32 v44, v44
    v_mfma_f32_16x16x32_bf16 v[36:39], a[84:87], v[132:135], v[36:39]
    v_mfma_f32_16x16x32_bf16 v[36:39], a[88:91], v[136:139], v[36:39]
    v_exp_f32 v45, v45
    v_mfma_f32_16x16x32_bf16 v[36:39], a[92:95], v[140:143], v[36:39]
    v_cvt_pk_bf16_f32 v56, v44, v45
    v_mfma_f32_16x16x32_bf16 v[40:43], a[96:99], v[128:131], 0
    v_exp_f32 v46, v46
    v_mfma_f32_16x16x32_bf16 v[40:43], a[100:103], v[132:135], v[40:43]
    v_mfma_f32_16x16x32_bf16 v[40:43], a[104:107], v[136:139], v[40:43]
    v_exp_f32 v47, v47
    v_mfma_f32_16x16x32_bf16 v[40:43], a[108:111], v[140:143], v[40:43]
    v_cvt_pk_bf16_f32 v57, v46, v47
    v_mfma_f32_16x16x32_bf16 v[176:179], a[144:147], v[52:55], 0
    v_exp_f32 v48, v48
    v_mfma_f32_16x16x32_bf16 v[180:183], a[148:151], v[52:55], 0
    v_mfma_f32_16x16x32_bf16 v[184:187], a[152:155], v[52:55], 0
    v_exp_f32 v49, v49
    v_mfma_f32_16x16x32_bf16 v[188:191], a[156:159], v[52:55], 0
    v_cvt_pk_bf16_f32 v58, v48, v49
    v_mfma_f32_16x16x32_bf16 a[216:219], v[24:27], v[52:55], 0
    v_mfma_f32_16x16x32_bf16 a[32:35], a[160:163], v[52:55], 0
    v_exp_f32 v50, v50
    v_mfma_f32_16x16x32_bf16 a[36:39], a[164:167], v[52:55], 0
    v_mfma_f32_16x16x32_bf16 a[40:43], a[168:171], v[52:55], 0
    v_exp_f32 v51, v51
    v_mfma_f32_16x16x32_bf16 a[44:47], a[172:175], v[52:55], 0
    v_cvt_pk_bf16_f32 v59, v50, v51
    s_waitcnt lgkmcnt(15)
    v_mfma_f32_16x16x32_bf16 v[44:47], a[112:115], v[64:67], 0
    s_add_u32 m0, s23, 114688
    v_exp_f32 v36, v36
    v_mfma_f32_16x16x32_bf16 v[44:47], a[116:119], v[68:71], v[44:47]
    buffer_load_dwordx4 v20, s[12:15], s24 offen offset:0  lds
    v_mfma_f32_16x16x32_bf16 v[44:47], a[120:123], v[72:75], v[44:47]
    v_exp_f32 v37, v37
    v_mfma_f32_16x16x32_bf16 v[44:47], a[124:127], v[76:79], v[44:47]
    v_mov_b32 v32, v36
    v_add_f32 v32, v32, v37
    v_mfma_f32_16x16x32_bf16 v[48:51], a[128:131], v[64:67], 0
    v_exp_f32 v38, v38
    v_mfma_f32_16x16x32_bf16 v[48:51], a[132:135], v[68:71], v[48:51]
    v_cvt_pk_bf16_f32 v52, v36, v37
    v_add_f32 v32, v32, v38
    v_mfma_f32_16x16x32_bf16 v[48:51], a[136:139], v[72:75], v[48:51]
    v_exp_f32 v39, v39
    v_mfma_f32_16x16x32_bf16 v[48:51], a[140:143], v[76:79], v[48:51]
    v_add_f32 v32, v32, v39
    v_cvt_pk_bf16_f32 v53, v38, v39
    v_mfma_f32_16x16x32_bf16 v[192:195], a[144:147], v[56:59], 0
    v_exp_f32 v40, v40
    v_mfma_f32_16x16x32_bf16 v[196:199], a[148:151], v[56:59], 0
    buffer_load_dwordx4 v21, s[12:15], s24 offen offset:1024  lds
    v_mfma_f32_16x16x32_bf16 v[200:203], a[152:155], v[56:59], 0
    v_exp_f32 v41, v41
    v_mfma_f32_16x16x32_bf16 v[204:207], a[156:159], v[56:59], 0
    v_add_f32 v32, v32, v40
    v_add_f32 v32, v32, v41
    v_mfma_f32_16x16x32_bf16 a[220:223], v[24:27], v[56:59], 0
    buffer_load_dwordx4 v20, s[12:15], s24 offen offset:2048  lds
    v_mfma_f32_16x16x32_bf16 a[48:51], a[160:163], v[56:59], 0
    v_exp_f32 v42, v42
    v_mfma_f32_16x16x32_bf16 a[52:55], a[164:167], v[56:59], 0
    v_cvt_pk_bf16_f32 v54, v40, v41
    v_add_f32 v32, v32, v42
    v_mfma_f32_16x16x32_bf16 a[56:59], a[168:171], v[56:59], 0
    v_exp_f32 v43, v43
    v_mfma_f32_16x16x32_bf16 a[60:63], a[172:175], v[56:59], 0
    v_add_f32 v32, v32, v43
    v_cvt_pk_bf16_f32 v55, v42, v43
    v_mfma_f32_16x16x32_bf16 v[36:39], a[112:115], v[80:83], 0
    v_exp_f32 v44, v44
    v_mfma_f32_16x16x32_bf16 v[36:39], a[116:119], v[84:87], v[36:39]
    buffer_load_dwordx4 v21, s[12:15], s24 offen offset:3072  lds
    v_mfma_f32_16x16x32_bf16 v[36:39], a[120:123], v[88:91], v[36:39]
    v_exp_f32 v45, v45
    v_mfma_f32_16x16x32_bf16 v[36:39], a[124:127], v[92:95], v[36:39]
    v_add_f32 v28, v28, v44
    v_add_f32 v28, v28, v45
    v_mfma_f32_16x16x32_bf16 v[40:43], a[128:131], v[80:83], 0
    v_exp_f32 v46, v46
    v_mfma_f32_16x16x32_bf16 v[40:43], a[132:135], v[84:87], v[40:43]
    v_cvt_pk_bf16_f32 v56, v44, v45
    v_add_f32 v28, v28, v46
    v_mfma_f32_16x16x32_bf16 v[40:43], a[136:139], v[88:91], v[40:43]
    v_exp_f32 v47, v47
    v_mfma_f32_16x16x32_bf16 v[40:43], a[140:143], v[92:95], v[40:43]
    v_add_f32 v28, v28, v47
    v_cvt_pk_bf16_f32 v57, v46, v47
    v_mfma_f32_16x16x32_bf16 v[208:211], a[144:147], v[52:55], 0
    v_exp_f32 v48, v48
    v_mfma_f32_16x16x32_bf16 v[212:215], a[148:151], v[52:55], 0
    v_mfma_f32_16x16x32_bf16 v[216:219], a[152:155], v[52:55], 0
    v_exp_f32 v49, v49
    v_mfma_f32_16x16x32_bf16 v[220:223], a[156:159], v[52:55], 0
    v_add_f32 v28, v28, v48
    v_add_f32 v28, v28, v49
    v_mfma_f32_16x16x32_bf16 a[64:67], a[160:163], v[52:55], 0
    v_exp_f32 v50, v50
    v_mfma_f32_16x16x32_bf16 a[68:71], a[164:167], v[52:55], 0
    v_cvt_pk_bf16_f32 v58, v48, v49
    v_add_f32 v28, v28, v50
    v_mfma_f32_16x16x32_bf16 a[72:75], a[168:171], v[52:55], 0
    v_exp_f32 v51, v51
    v_mfma_f32_16x16x32_bf16 a[76:79], a[172:175], v[52:55], 0
    v_add_f32 v28, v28, v51
    v_cvt_pk_bf16_f32 v59, v50, v51
    v_mfma_f32_16x16x32_bf16 v[44:47], a[112:115], v[96:99], 0
    v_exp_f32 v36, v36
    v_mfma_f32_16x16x32_bf16 v[44:47], a[116:119], v[100:103], v[44:47]
    v_mfma_f32_16x16x32_bf16 v[44:47], a[120:123], v[104:107], v[44:47]
    v_exp_f32 v37, v37
    v_mfma_f32_16x16x32_bf16 v[44:47], a[124:127], v[108:111], v[44:47]
    v_add_f32 v29, v29, v36
    v_add_f32 v29, v29, v37
    v_mfma_f32_16x16x32_bf16 v[48:51], a[128:131], v[96:99], 0
    v_exp_f32 v38, v38
    v_mfma_f32_16x16x32_bf16 v[48:51], a[132:135], v[100:103], v[48:51]
    v_cvt_pk_bf16_f32 v52, v36, v37
    v_add_f32 v29, v29, v38
    v_mfma_f32_16x16x32_bf16 v[48:51], a[136:139], v[104:107], v[48:51]
    v_exp_f32 v39, v39
    v_mfma_f32_16x16x32_bf16 v[48:51], a[140:143], v[108:111], v[48:51]
    s_waitcnt vmcnt(8) lgkmcnt(0)
    s_barrier
    v_add_f32 v29, v29, v39
    v_cvt_pk_bf16_f32 v53, v38, v39
    v_mfma_f32_16x16x32_bf16 v[144:147], a[176:179], v[56:59], v[144:147]
    s_add_u32 s24, s24, 16384
    s_add_u32 m0, s23, 0
    v_exp_f32 v40, v40
    v_mfma_f32_16x16x32_bf16 v[148:151], a[180:183], v[56:59], v[148:151]
    buffer_load_dwordx4 v20, s[8:11], s24 offen offset:0  lds
    v_mfma_f32_16x16x32_bf16 v[152:155], a[184:187], v[56:59], v[152:155]
    v_exp_f32 v41, v41
    v_mfma_f32_16x16x32_bf16 v[156:159], a[188:191], v[56:59], v[156:159]
    v_add_f32 v29, v29, v40
    v_add_f32 v29, v29, v41
    v_mfma_f32_16x16x32_bf16 a[0:3], a[192:195], v[56:59], a[0:3]
    v_exp_f32 v42, v42
    v_mfma_f32_16x16x32_bf16 a[4:7], a[196:199], v[56:59], a[4:7]
    v_cvt_pk_bf16_f32 v54, v40, v41
    v_add_f32 v29, v29, v42
    v_mfma_f32_16x16x32_bf16 a[8:11], a[200:203], v[56:59], a[8:11]
    v_exp_f32 v43, v43
    v_mfma_f32_16x16x32_bf16 a[12:15], a[204:207], v[56:59], a[12:15]
    v_add_f32 v29, v29, v43
    v_cvt_pk_bf16_f32 v55, v42, v43
    v_mfma_f32_16x16x32_bf16 v[36:39], a[112:115], v[112:115], 0
    v_exp_f32 v44, v44
    v_mfma_f32_16x16x32_bf16 v[36:39], a[116:119], v[116:119], v[36:39]
    buffer_load_dwordx4 v21, s[8:11], s24 offen offset:1024  lds
    v_mfma_f32_16x16x32_bf16 v[36:39], a[120:123], v[120:123], v[36:39]
    v_exp_f32 v45, v45
    v_mfma_f32_16x16x32_bf16 v[36:39], a[124:127], v[124:127], v[36:39]
    ds_read_b128 a[80:83], v8 offset:32768
    v_cvt_pk_bf16_f32 v56, v44, v45
    v_mfma_f32_16x16x32_bf16 v[40:43], a[128:131], v[112:115], 0
    v_exp_f32 v46, v46
    v_mfma_f32_16x16x32_bf16 v[40:43], a[132:135], v[116:119], v[40:43]
    buffer_load_dwordx4 v20, s[8:11], s24 offen offset:2048  lds
    v_mfma_f32_16x16x32_bf16 v[40:43], a[136:139], v[120:123], v[40:43]
    v_exp_f32 v47, v47
    v_mfma_f32_16x16x32_bf16 v[40:43], a[140:143], v[124:127], v[40:43]
    ds_read_b128 a[84:87], v9 offset:32768
    v_cvt_pk_bf16_f32 v57, v46, v47
    v_mfma_f32_16x16x32_bf16 v[160:163], a[176:179], v[52:55], v[160:163]
    v_exp_f32 v48, v48
    v_mfma_f32_16x16x32_bf16 v[164:167], a[180:183], v[52:55], v[164:167]
    buffer_load_dwordx4 v21, s[8:11], s24 offen offset:3072  lds
    v_mfma_f32_16x16x32_bf16 v[168:171], a[184:187], v[52:55], v[168:171]
    v_exp_f32 v49, v49
    v_mfma_f32_16x16x32_bf16 v[172:175], a[188:191], v[52:55], v[172:175]
    ds_read_b128 a[88:91], v10 offset:32768
    v_cvt_pk_bf16_f32 v58, v48, v49
    v_mfma_f32_16x16x32_bf16 a[16:19], a[192:195], v[52:55], a[16:19]
    v_exp_f32 v50, v50
    v_mfma_f32_16x16x32_bf16 a[20:23], a[196:199], v[52:55], a[20:23]
    ds_read_b128 a[92:95], v11 offset:32768
    ds_read_b128 a[96:99], v8 offset:36864
    v_mfma_f32_16x16x32_bf16 a[24:27], a[200:203], v[52:55], a[24:27]
    v_exp_f32 v51, v51
    v_mfma_f32_16x16x32_bf16 a[28:31], a[204:207], v[52:55], a[28:31]
    ds_read_b128 a[100:103], v9 offset:36864
    v_cvt_pk_bf16_f32 v59, v50, v51
    v_mfma_f32_16x16x32_bf16 v[44:47], a[112:115], v[128:131], 0
    s_add_u32 m0, s23, 65536
    v_exp_f32 v36, v36
    v_mfma_f32_16x16x32_bf16 v[44:47], a[116:119], v[132:135], v[44:47]
    buffer_load_dwordx4 v20, s[12:15], s24 offen offset:0  lds
    v_mfma_f32_16x16x32_bf16 v[44:47], a[120:123], v[136:139], v[44:47]
    v_exp_f32 v37, v37
    v_mfma_f32_16x16x32_bf16 v[44:47], a[124:127], v[140:143], v[44:47]
    ds_read_b128 a[104:107], v10 offset:36864
    v_cvt_pk_bf16_f32 v52, v36, v37
    v_mfma_f32_16x16x32_bf16 v[48:51], a[128:131], v[128:131], 0
    v_exp_f32 v38, v38
    v_mfma_f32_16x16x32_bf16 v[48:51], a[132:135], v[132:135], v[48:51]
    buffer_load_dwordx4 v21, s[12:15], s24 offen offset:1024  lds
    v_mfma_f32_16x16x32_bf16 v[48:51], a[136:139], v[136:139], v[48:51]
    v_exp_f32 v39, v39
    v_mfma_f32_16x16x32_bf16 v[48:51], a[140:143], v[140:143], v[48:51]
    ds_read_b128 a[108:111], v11 offset:36864
    v_cvt_pk_bf16_f32 v53, v38, v39
    v_mfma_f32_16x16x32_bf16 v[176:179], a[176:179], v[56:59], v[176:179]
    v_exp_f32 v40, v40
    v_mfma_f32_16x16x32_bf16 v[180:183], a[180:183], v[56:59], v[180:183]
    buffer_load_dwordx4 v20, s[12:15], s24 offen offset:2048  lds
    v_mfma_f32_16x16x32_bf16 v[184:187], a[184:187], v[56:59], v[184:187]
    v_exp_f32 v41, v41
    v_mfma_f32_16x16x32_bf16 v[188:191], a[188:191], v[56:59], v[188:191]
    ds_read_b64_tr_b16 a[144:145], v12 offset:32768
    v_cvt_pk_bf16_f32 v54, v40, v41
    v_mfma_f32_16x16x32_bf16 a[216:219], v[24:27], v[56:59], a[216:219]
    buffer_load_dwordx4 v21, s[12:15], s24 offen offset:3072  lds
    v_mfma_f32_16x16x32_bf16 a[32:35], a[192:195], v[56:59], a[32:35]
    v_exp_f32 v42, v42
    v_mfma_f32_16x16x32_bf16 a[36:39], a[196:199], v[56:59], a[36:39]
    ds_read_b64_tr_b16 a[146:147], v12 offset:36864
    ds_read_b64_tr_b16 a[148:149], v13 offset:32768
    v_mfma_f32_16x16x32_bf16 a[40:43], a[200:203], v[56:59], a[40:43]
    v_exp_f32 v43, v43
    v_mfma_f32_16x16x32_bf16 a[44:47], a[204:207], v[56:59], a[44:47]
    ds_read_b64_tr_b16 a[150:151], v13 offset:36864
    v_cvt_pk_bf16_f32 v55, v42, v43
    s_waitcnt lgkmcnt(4)
    v_mfma_f32_16x16x32_bf16 v[36:39], a[80:83], v[64:67], 0
    v_exp_f32 v44, v44
    v_mfma_f32_16x16x32_bf16 v[36:39], a[84:87], v[68:71], v[36:39]
    ds_read_b64_tr_b16 a[152:153], v14 offset:32768
    ds_read_b64_tr_b16 a[154:155], v14 offset:36864
    v_mfma_f32_16x16x32_bf16 v[36:39], a[88:91], v[72:75], v[36:39]
    v_exp_f32 v45, v45
    v_mfma_f32_16x16x32_bf16 v[36:39], a[92:95], v[76:79], v[36:39]
    v_add_f32 v32, v32, v44
    v_add_f32 v32, v32, v45
    v_mfma_f32_16x16x32_bf16 v[40:43], a[96:99], v[64:67], 0
    v_exp_f32 v46, v46
    v_mfma_f32_16x16x32_bf16 v[40:43], a[100:103], v[68:71], v[40:43]
    v_cvt_pk_bf16_f32 v56, v44, v45
    v_add_f32 v32, v32, v46
    v_mfma_f32_16x16x32_bf16 v[40:43], a[104:107], v[72:75], v[40:43]
    v_exp_f32 v47, v47
    v_mfma_f32_16x16x32_bf16 v[40:43], a[108:111], v[76:79], v[40:43]
    v_add_f32 v32, v32, v47
    v_cvt_pk_bf16_f32 v57, v46, v47
    v_mfma_f32_16x16x32_bf16 v[192:195], a[176:179], v[52:55], v[192:195]
    v_exp_f32 v48, v48
    v_mfma_f32_16x16x32_bf16 v[196:199], a[180:183], v[52:55], v[196:199]
    ds_read_b64_tr_b16 a[156:157], v15 offset:32768
    ds_read_b64_tr_b16 a[158:159], v15 offset:36864
    v_mfma_f32_16x16x32_bf16 v[200:203], a[184:187], v[52:55], v[200:203]
    v_exp_f32 v49, v49
    v_mfma_f32_16x16x32_bf16 v[204:207], a[188:191], v[52:55], v[204:207]
    v_add_f32 v32, v32, v48
    v_add_f32 v32, v32, v49
    v_mfma_f32_16x16x32_bf16 a[220:223], v[24:27], v[52:55], a[220:223]
    ds_read_b64_tr_b16 a[160:161], v16 offset:32768
    ds_read_b64_tr_b16 a[162:163], v16 offset:36864
    v_mfma_f32_16x16x32_bf16 a[48:51], a[192:195], v[52:55], a[48:51]
    v_exp_f32 v50, v50
    v_mfma_f32_16x16x32_bf16 a[52:55], a[196:199], v[52:55], a[52:55]
    v_cvt_pk_bf16_f32 v58, v48, v49
    v_add_f32 v32, v32, v50
    v_mfma_f32_16x16x32_bf16 a[56:59], a[200:203], v[52:55], a[56:59]
    v_exp_f32 v51, v51
    v_mfma_f32_16x16x32_bf16 a[60:63], a[204:207], v[52:55], a[60:63]
    v_add_f32 v32, v32, v51
    v_cvt_pk_bf16_f32 v59, v50, v51
.p2align 6
L_top:
    v_mfma_f32_16x16x32_bf16 v[44:47], a[80:83], v[80:83], 0
    v_exp_f32 v36, v36
    v_mfma_f32_16x16x32_bf16 v[44:47], a[84:87], v[84:87], v[44:47]
    ds_read_b64_tr_b16 a[164:165], v17 offset:32768
    ds_read_b64_tr_b16 a[166:167], v17 offset:36864
    v_mfma_f32_16x16x32_bf16 v[44:47], a[88:91], v[88:91], v[44:47]
    v_exp_f32 v37, v37
    v_mfma_f32_16x16x32_bf16 v[44:47], a[92:95], v[92:95], v[44:47]
    v_add_f32 v28, v28, v36
    v_add_f32 v28, v28, v37
    v_mfma_f32_16x16x32_bf16 v[48:51], a[96:99], v[80:83], 0
    v_exp_f32 v38, v38
    v_mfma_f32_16x16x32_bf16 v[48:51], a[100:103], v[84:87], v[48:51]
    v_cvt_pk_bf16_f32 v52, v36, v37
    v_add_f32 v28, v28, v38
    v_mfma_f32_16x16x32_bf16 v[48:51], a[104:107], v[88:91], v[48:51]
    v_exp_f32 v39, v39
    v_mfma_f32_16x16x32_bf16 v[48:51], a[108:111], v[92:95], v[48:51]
    v_add_f32 v28, v28, v39
    v_cvt_pk_bf16_f32 v53, v38, v39
    v_mfma_f32_16x16x32_bf16 v[208:211], a[176:179], v[56:59], v[208:211]
    v_exp_f32 v40, v40
    v_mfma_f32_16x16x32_bf16 v[212:215], a[180:183], v[56:59], v[212:215]
    ds_read_b64_tr_b16 a[168:169], v18 offset:32768
    ds_read_b64_tr_b16 a[170:171], v18 offset:36864
    v_mfma_f32_16x16x32_bf16 v[216:219], a[184:187], v[56:59], v[216:219]
    v_exp_f32 v41, v41
    v_mfma_f32_16x16x32_bf16 v[220:223], a[188:191], v[56:59], v[220:223]
    v_add_f32 v28, v28, v40
    v_add_f32 v28, v28, v41
    v_mfma_f32_16x16x32_bf16 a[64:67], a[192:195], v[56:59], a[64:67]
    v_exp_f32 v42, v42
    v_mfma_f32_16x16x32_bf16 a[68:71], a[196:199], v[56:59], a[68:71]
    v_cvt_pk_bf16_f32 v54, v40, v41
    v_add_f32 v28, v28, v42
    v_mfma_f32_16x16x32_bf16 a[72:75], a[200:203], v[56:59], a[72:75]
    v_exp_f32 v43, v43
    v_mfma_f32_16x16x32_bf16 a[76:79], a[204:207], v[56:59], a[76:79]
    v_add_f32 v28, v28, v43
    v_cvt_pk_bf16_f32 v55, v42, v43
    global_load_dword v62, v23, s[60:61]
    global_load_dword v63, v23, s[60:61] offset:64
    v_mfma_f32_16x16x32_bf16 v[36:39], a[80:83], v[96:99], 0
    v_exp_f32 v44, v44
    v_mfma_f32_16x16x32_bf16 v[36:39], a[84:87], v[100:103], v[36:39]
    ds_read_b64_tr_b16 a[172:173], v19 offset:32768
    ds_read_b64_tr_b16 a[174:175], v19 offset:36864
    v_mfma_f32_16x16x32_bf16 v[36:39], a[88:91], v[104:107], v[36:39]
    v_exp_f32 v45, v45
    v_mfma_f32_16x16x32_bf16 v[36:39], a[92:95], v[108:111], v[36:39]
    v_add_f32 v29, v29, v44
    v_add_f32 v29, v29, v45
    v_mfma_f32_16x16x32_bf16 v[40:43], a[96:99], v[96:99], 0
    v_exp_f32 v46, v46
    v_mfma_f32_16x16x32_bf16 v[40:43], a[100:103], v[100:103], v[40:43]
    v_cvt_pk_bf16_f32 v56, v44, v45
    v_add_f32 v29, v29, v46
    v_mfma_f32_16x16x32_bf16 v[40:43], a[104:107], v[104:107], v[40:43]
    v_exp_f32 v47, v47
    v_mfma_f32_16x16x32_bf16 v[40:43], a[108:111], v[108:111], v[40:43]
    s_waitcnt vmcnt(8) lgkmcnt(0)
    s_barrier
    s_add_u32 s24, s24, 16384
    v_add_f32 v29, v29, v47
    v_cvt_pk_bf16_f32 v57, v46, v47
    v_mfma_f32_16x16x32_bf16 v[144:147], a[144:147], v[52:55], v[144:147]
    s_add_u32 m0, s23, 16384
    v_exp_f32 v48, v48
    v_mfma_f32_16x16x32_bf16 v[148:151], a[148:151], v[52:55], v[148:151]
    buffer_load_dwordx4 v20, s[8:11], s24 offen offset:0  lds
    v_mfma_f32_16x16x32_bf16 v[152:155], a[152:155], v[52:55], v[152:155]
    v_exp_f32 v49, v49
    v_mfma_f32_16x16x32_bf16 v[156:159], a[156:159], v[52:55], v[156:159]
    v_add_f32 v29, v29, v48
    v_add_f32 v29, v29, v49
    v_mfma_f32_16x16x32_bf16 a[0:3], a[160:163], v[52:55], a[0:3]
    v_exp_f32 v50, v50
    v_mfma_f32_16x16x32_bf16 a[4:7], a[164:167], v[52:55], a[4:7]
    v_cvt_pk_bf16_f32 v58, v48, v49
    v_add_f32 v29, v29, v50
    v_mfma_f32_16x16x32_bf16 a[8:11], a[168:171], v[52:55], a[8:11]
    v_exp_f32 v51, v51
    v_mfma_f32_16x16x32_bf16 a[12:15], a[172:175], v[52:55], a[12:15]
    v_add_f32 v29, v29, v51
    v_cvt_pk_bf16_f32 v59, v50, v51
    v_mfma_f32_16x16x32_bf16 v[44:47], a[80:83], v[112:115], 0
    v_exp_f32 v36, v36
    v_mfma_f32_16x16x32_bf16 v[44:47], a[84:87], v[116:119], v[44:47]
    buffer_load_dwordx4 v21, s[8:11], s24 offen offset:1024  lds
    v_mfma_f32_16x16x32_bf16 v[44:47], a[88:91], v[120:123], v[44:47]
    v_exp_f32 v37, v37
    v_mfma_f32_16x16x32_bf16 v[44:47], a[92:95], v[124:127], v[44:47]
    ds_read_b128 a[112:115], v8 offset:49152
    v_cvt_pk_bf16_f32 v52, v36, v37
    v_mfma_f32_16x16x32_bf16 v[48:51], a[96:99], v[112:115], 0
    v_exp_f32 v38, v38
    v_mfma_f32_16x16x32_bf16 v[48:51], a[100:103], v[116:119], v[48:51]
    buffer_load_dwordx4 v20, s[8:11], s24 offen offset:2048  lds
    v_mfma_f32_16x16x32_bf16 v[48:51], a[104:107], v[120:123], v[48:51]
    v_exp_f32 v39, v39
    v_mfma_f32_16x16x32_bf16 v[48:51], a[108:111], v[124:127], v[48:51]
    ds_read_b128 a[116:119], v9 offset:49152
    v_cvt_pk_bf16_f32 v53, v38, v39
    v_mfma_f32_16x16x32_bf16 v[160:163], a[144:147], v[56:59], v[160:163]
    v_exp_f32 v40, v40
    v_mfma_f32_16x16x32_bf16 v[164:167], a[148:151], v[56:59], v[164:167]
    buffer_load_dwordx4 v21, s[8:11], s24 offen offset:3072  lds
    v_mfma_f32_16x16x32_bf16 v[168:171], a[152:155], v[56:59], v[168:171]
    v_exp_f32 v41, v41
    v_mfma_f32_16x16x32_bf16 v[172:175], a[156:159], v[56:59], v[172:175]
    ds_read_b128 a[120:123], v10 offset:49152
    v_cvt_pk_bf16_f32 v54, v40, v41
    v_mfma_f32_16x16x32_bf16 a[16:19], a[160:163], v[56:59], a[16:19]
    v_exp_f32 v42, v42
    v_mfma_f32_16x16x32_bf16 a[20:23], a[164:167], v[56:59], a[20:23]
    ds_read_b128 a[124:127], v11 offset:49152
    ds_read_b128 a[128:131], v8 offset:53248
    v_mfma_f32_16x16x32_bf16 a[24:27], a[168:171], v[56:59], a[24:27]
    v_exp_f32 v43, v43
    v_mfma_f32_16x16x32_bf16 a[28:31], a[172:175], v[56:59], a[28:31]
    ds_read_b128 a[132:135], v9 offset:53248
    v_cvt_pk_bf16_f32 v55, v42, v43
    v_mfma_f32_16x16x32_bf16 v[36:39], a[80:83], v[128:131], 0
    s_add_u32 m0, s23, 81920
    v_exp_f32 v44, v44
    v_mfma_f32_16x16x32_bf16 v[36:39], a[84:87], v[132:135], v[36:39]
    buffer_load_dwordx4 v20, s[12:15], s24 offen offset:0  lds
    v_mfma_f32_16x16x32_bf16 v[36:39], a[88:91], v[136:139], v[36:39]
    v_exp_f32 v45, v45
    v_mfma_f32_16x16x32_bf16 v[36:39], a[92:95], v[140:143], v[36:39]
    ds_read_b128 a[136:139], v10 offset:53248
    v_cvt_pk_bf16_f32 v56, v44, v45
    v_mfma_f32_16x16x32_bf16 v[40:43], a[96:99], v[128:131], 0
    v_exp_f32 v46, v46
    v_mfma_f32_16x16x32_bf16 v[40:43], a[100:103], v[132:135], v[40:43]
    buffer_load_dwordx4 v21, s[12:15], s24 offen offset:1024  lds
    v_mfma_f32_16x16x32_bf16 v[40:43], a[104:107], v[136:139], v[40:43]
    v_exp_f32 v47, v47
    v_mfma_f32_16x16x32_bf16 v[40:43], a[108:111], v[140:143], v[40:43]
    ds_read_b128 a[140:143], v11 offset:53248
    v_cvt_pk_bf16_f32 v57, v46, v47
    v_mfma_f32_16x16x32_bf16 v[176:179], a[144:147], v[52:55], v[176:179]
    v_exp_f32 v48, v48
    v_mfma_f32_16x16x32_bf16 v[180:183], a[148:151], v[52:55], v[180:183]
    buffer_load_dwordx4 v20, s[12:15], s24 offen offset:2048  lds
    v_mfma_f32_16x16x32_bf16 v[184:187], a[152:155], v[52:55], v[184:187]
    v_exp_f32 v49, v49
    v_mfma_f32_16x16x32_bf16 v[188:191], a[156:159], v[52:55], v[188:191]
    ds_read_b64_tr_b16 a[176:177], v12 offset:49152
    v_cvt_pk_bf16_f32 v58, v48, v49
    v_mfma_f32_16x16x32_bf16 a[216:219], v[24:27], v[52:55], a[216:219]
    buffer_load_dwordx4 v21, s[12:15], s24 offen offset:3072  lds
    v_mfma_f32_16x16x32_bf16 a[32:35], a[160:163], v[52:55], a[32:35]
    v_exp_f32 v50, v50
    v_mfma_f32_16x16x32_bf16 a[36:39], a[164:167], v[52:55], a[36:39]
    ds_read_b64_tr_b16 a[178:179], v12 offset:53248
    ds_read_b64_tr_b16 a[180:181], v13 offset:49152
    v_mfma_f32_16x16x32_bf16 a[40:43], a[168:171], v[52:55], a[40:43]
    v_exp_f32 v51, v51
    v_mfma_f32_16x16x32_bf16 a[44:47], a[172:175], v[52:55], a[44:47]
    ds_read_b64_tr_b16 a[182:183], v13 offset:53248
    v_cvt_pk_bf16_f32 v59, v50, v51
    s_waitcnt lgkmcnt(4)
    v_mfma_f32_16x16x32_bf16 v[44:47], a[112:115], v[64:67], 0
    v_exp_f32 v36, v36
    v_mfma_f32_16x16x32_bf16 v[44:47], a[116:119], v[68:71], v[44:47]
    ds_read_b64_tr_b16 a[184:185], v14 offset:49152
    ds_read_b64_tr_b16 a[186:187], v14 offset:53248
    v_mfma_f32_16x16x32_bf16 v[44:47], a[120:123], v[72:75], v[44:47]
    v_exp_f32 v37, v37
    v_mfma_f32_16x16x32_bf16 v[44:47], a[124:127], v[76:79], v[44:47]
    v_add_f32 v32, v32, v36
    v_add_f32 v32, v32, v37
    v_mfma_f32_16x16x32_bf16 v[48:51], a[128:131], v[64:67], 0
    v_exp_f32 v38, v38
    v_mfma_f32_16x16x32_bf16 v[48:51], a[132:135], v[68:71], v[48:51]
    v_cvt_pk_bf16_f32 v52, v36, v37
    v_add_f32 v32, v32, v38
    v_mfma_f32_16x16x32_bf16 v[48:51], a[136:139], v[72:75], v[48:51]
    v_exp_f32 v39, v39
    v_mfma_f32_16x16x32_bf16 v[48:51], a[140:143], v[76:79], v[48:51]
    v_add_f32 v32, v32, v39
    v_cvt_pk_bf16_f32 v53, v38, v39
    v_mfma_f32_16x16x32_bf16 v[192:195], a[144:147], v[56:59], v[192:195]
    v_exp_f32 v40, v40
    v_mfma_f32_16x16x32_bf16 v[196:199], a[148:151], v[56:59], v[196:199]
    ds_read_b64_tr_b16 a[188:189], v15 offset:49152
    ds_read_b64_tr_b16 a[190:191], v15 offset:53248
    v_mfma_f32_16x16x32_bf16 v[200:203], a[152:155], v[56:59], v[200:203]
    v_exp_f32 v41, v41
    v_mfma_f32_16x16x32_bf16 v[204:207], a[156:159], v[56:59], v[204:207]
    v_add_f32 v32, v32, v40
    v_add_f32 v32, v32, v41
    v_mfma_f32_16x16x32_bf16 a[220:223], v[24:27], v[56:59], a[220:223]
    ds_read_b64_tr_b16 a[192:193], v16 offset:49152
    ds_read_b64_tr_b16 a[194:195], v16 offset:53248
    v_mfma_f32_16x16x32_bf16 a[48:51], a[160:163], v[56:59], a[48:51]
    v_exp_f32 v42, v42
    v_mfma_f32_16x16x32_bf16 a[52:55], a[164:167], v[56:59], a[52:55]
    v_cvt_pk_bf16_f32 v54, v40, v41
    v_add_f32 v32, v32, v42
    v_mfma_f32_16x16x32_bf16 a[56:59], a[168:171], v[56:59], a[56:59]
    v_exp_f32 v43, v43
    v_mfma_f32_16x16x32_bf16 a[60:63], a[172:175], v[56:59], a[60:63]
    v_add_f32 v32, v32, v43
    v_cvt_pk_bf16_f32 v55, v42, v43
    v_mfma_f32_16x16x32_bf16 v[36:39], a[112:115], v[80:83], 0
    v_exp_f32 v44, v44
    v_mfma_f32_16x16x32_bf16 v[36:39], a[116:119], v[84:87], v[36:39]
    ds_read_b64_tr_b16 a[196:197], v17 offset:49152
    ds_read_b64_tr_b16 a[198:199], v17 offset:53248
    v_mfma_f32_16x16x32_bf16 v[36:39], a[120:123], v[88:91], v[36:39]
    v_exp_f32 v45, v45
    v_mfma_f32_16x16x32_bf16 v[36:39], a[124:127], v[92:95], v[36:39]
    v_add_f32 v28, v28, v44
    v_add_f32 v28, v28, v45
    v_mfma_f32_16x16x32_bf16 v[40:43], a[128:131], v[80:83], 0
    v_exp_f32 v46, v46
    v_mfma_f32_16x16x32_bf16 v[40:43], a[132:135], v[84:87], v[40:43]
    v_cvt_pk_bf16_f32 v56, v44, v45
    v_add_f32 v28, v28, v46
    v_mfma_f32_16x16x32_bf16 v[40:43], a[136:139], v[88:91], v[40:43]
    v_exp_f32 v47, v47
    v_mfma_f32_16x16x32_bf16 v[40:43], a[140:143], v[92:95], v[40:43]
    v_add_f32 v28, v28, v47
    v_cvt_pk_bf16_f32 v57, v46, v47
    v_mfma_f32_16x16x32_bf16 v[208:211], a[144:147], v[52:55], v[208:211]
    v_exp_f32 v48, v48
    v_mfma_f32_16x16x32_bf16 v[212:215], a[148:151], v[52:55], v[212:215]
    ds_read_b64_tr_b16 a[200:201], v18 offset:49152
    ds_read_b64_tr_b16 a[202:203], v18 offset:53248
    v_mfma_f32_16x16x32_bf16 v[216:219], a[152:155], v[52:55], v[216:219]
    v_exp_f32 v49, v49
    v_mfma_f32_16x16x32_bf16 v[220:223], a[156:159], v[52:55], v[220:223]
    v_add_f32 v28, v28, v48
    v_add_f32 v28, v28, v49
    v_mfma_f32_16x16x32_bf16 a[64:67], a[160:163], v[52:55], a[64:67]
    v_exp_f32 v50, v50
    v_mfma_f32_16x16x32_bf16 a[68:71], a[164:167], v[52:55], a[68:71]
    v_cvt_pk_bf16_f32 v58, v48, v49
    v_add_f32 v28, v28, v50
    v_mfma_f32_16x16x32_bf16 a[72:75], a[168:171], v[52:55], a[72:75]
    v_exp_f32 v51, v51
    v_mfma_f32_16x16x32_bf16 a[76:79], a[172:175], v[52:55], a[76:79]
    v_add_f32 v28, v28, v51
    v_cvt_pk_bf16_f32 v59, v50, v51
    v_mfma_f32_16x16x32_bf16 v[44:47], a[112:115], v[96:99], 0
    v_exp_f32 v36, v36
    v_mfma_f32_16x16x32_bf16 v[44:47], a[116:119], v[100:103], v[44:47]
    ds_read_b64_tr_b16 a[204:205], v19 offset:49152
    ds_read_b64_tr_b16 a[206:207], v19 offset:53248
    v_mfma_f32_16x16x32_bf16 v[44:47], a[120:123], v[104:107], v[44:47]
    v_exp_f32 v37, v37
    v_mfma_f32_16x16x32_bf16 v[44:47], a[124:127], v[108:111], v[44:47]
    v_add_f32 v29, v29, v36
    v_add_f32 v29, v29, v37
    v_mfma_f32_16x16x32_bf16 v[48:51], a[128:131], v[96:99], 0
    v_exp_f32 v38, v38
    v_mfma_f32_16x16x32_bf16 v[48:51], a[132:135], v[100:103], v[48:51]
    v_cvt_pk_bf16_f32 v52, v36, v37
    v_add_f32 v29, v29, v38
    v_mfma_f32_16x16x32_bf16 v[48:51], a[136:139], v[104:107], v[48:51]
    v_exp_f32 v39, v39
    v_mfma_f32_16x16x32_bf16 v[48:51], a[140:143], v[108:111], v[48:51]
    s_waitcnt vmcnt(8) lgkmcnt(0)
    s_barrier
    s_add_u32 s24, s24, 16384
    v_add_f32 v29, v29, v39
    v_cvt_pk_bf16_f32 v53, v38, v39
    v_mfma_f32_16x16x32_bf16 v[144:147], a[176:179], v[56:59], v[144:147]
    s_add_u32 m0, s23, 32768
    v_exp_f32 v40, v40
    v_mfma_f32_16x16x32_bf16 v[148:151], a[180:183], v[56:59], v[148:151]
    buffer_load_dwordx4 v20, s[8:11], s24 offen offset:0  lds
    v_mfma_f32_16x16x32_bf16 v[152:155], a[184:187], v[56:59], v[152:155]
    v_exp_f32 v41, v41
    v_mfma_f32_16x16x32_bf16 v[156:159], a[188:191], v[56:59], v[156:159]
    v_add_f32 v29, v29, v40
    v_add_f32 v29, v29, v41
    v_mfma_f32_16x16x32_bf16 a[0:3], a[192:195], v[56:59], a[0:3]
    v_exp_f32 v42, v42
    v_mfma_f32_16x16x32_bf16 a[4:7], a[196:199], v[56:59], a[4:7]
    v_cvt_pk_bf16_f32 v54, v40, v41
    v_add_f32 v29, v29, v42
    v_mfma_f32_16x16x32_bf16 a[8:11], a[200:203], v[56:59], a[8:11]
    v_exp_f32 v43, v43
    v_mfma_f32_16x16x32_bf16 a[12:15], a[204:207], v[56:59], a[12:15]
    v_add_f32 v29, v29, v43
    v_cvt_pk_bf16_f32 v55, v42, v43
    v_mfma_f32_16x16x32_bf16 v[36:39], a[112:115], v[112:115], 0
    v_exp_f32 v44, v44
    v_mfma_f32_16x16x32_bf16 v[36:39], a[116:119], v[116:119], v[36:39]
    buffer_load_dwordx4 v21, s[8:11], s24 offen offset:1024  lds
    v_mfma_f32_16x16x32_bf16 v[36:39], a[120:123], v[120:123], v[36:39]
    v_exp_f32 v45, v45
    v_mfma_f32_16x16x32_bf16 v[36:39], a[124:127], v[124:127], v[36:39]
    ds_read_b128 a[80:83], v8 offset:0
    v_cvt_pk_bf16_f32 v56, v44, v45
    v_mfma_f32_16x16x32_bf16 v[40:43], a[128:131], v[112:115], 0
    v_exp_f32 v46, v46
    v_mfma_f32_16x16x32_bf16 v[40:43], a[132:135], v[116:119], v[40:43]
    buffer_load_dwordx4 v20, s[8:11], s24 offen offset:2048  lds
    v_mfma_f32_16x16x32_bf16 v[40:43], a[136:139], v[120:123], v[40:43]
    v_exp_f32 v47, v47
    v_mfma_f32_16x16x32_bf16 v[40:43], a[140:143], v[124:127], v[40:43]
    ds_read_b128 a[84:87], v9 offset:0
    v_cvt_pk_bf16_f32 v57, v46, v47
    v_mfma_f32_16x16x32_bf16 v[160:163], a[176:179], v[52:55], v[160:163]
    v_exp_f32 v48, v48
    v_mfma_f32_16x16x32_bf16 v[164:167], a[180:183], v[52:55], v[164:167]
    buffer_load_dwordx4 v21, s[8:11], s24 offen offset:3072  lds
    v_mfma_f32_16x16x32_bf16 v[168:171], a[184:187], v[52:55], v[168:171]
    v_exp_f32 v49, v49
    v_mfma_f32_16x16x32_bf16 v[172:175], a[188:191], v[52:55], v[172:175]
    ds_read_b128 a[88:91], v10 offset:0
    v_cvt_pk_bf16_f32 v58, v48, v49
    v_mfma_f32_16x16x32_bf16 a[16:19], a[192:195], v[52:55], a[16:19]
    v_exp_f32 v50, v50
    v_mfma_f32_16x16x32_bf16 a[20:23], a[196:199], v[52:55], a[20:23]
    ds_read_b128 a[92:95], v11 offset:0
    ds_read_b128 a[96:99], v8 offset:4096
    v_mfma_f32_16x16x32_bf16 a[24:27], a[200:203], v[52:55], a[24:27]
    v_exp_f32 v51, v51
    v_mfma_f32_16x16x32_bf16 a[28:31], a[204:207], v[52:55], a[28:31]
    ds_read_b128 a[100:103], v9 offset:4096
    v_cvt_pk_bf16_f32 v59, v50, v51
    v_mfma_f32_16x16x32_bf16 v[44:47], a[112:115], v[128:131], 0
    s_add_u32 m0, s23, 98304
    v_exp_f32 v36, v36
    v_mfma_f32_16x16x32_bf16 v[44:47], a[116:119], v[132:135], v[44:47]
    buffer_load_dwordx4 v20, s[12:15], s24 offen offset:0  lds
    v_mfma_f32_16x16x32_bf16 v[44:47], a[120:123], v[136:139], v[44:47]
    v_exp_f32 v37, v37
    v_mfma_f32_16x16x32_bf16 v[44:47], a[124:127], v[140:143], v[44:47]
    ds_read_b128 a[104:107], v10 offset:4096
    v_cvt_pk_bf16_f32 v52, v36, v37
    v_mfma_f32_16x16x32_bf16 v[48:51], a[128:131], v[128:131], 0
    v_exp_f32 v38, v38
    v_mfma_f32_16x16x32_bf16 v[48:51], a[132:135], v[132:135], v[48:51]
    buffer_load_dwordx4 v21, s[12:15], s24 offen offset:1024  lds
    v_mfma_f32_16x16x32_bf16 v[48:51], a[136:139], v[136:139], v[48:51]
    v_exp_f32 v39, v39
    v_mfma_f32_16x16x32_bf16 v[48:51], a[140:143], v[140:143], v[48:51]
    ds_read_b128 a[108:111], v11 offset:4096
    v_cvt_pk_bf16_f32 v53, v38, v39
    v_mfma_f32_16x16x32_bf16 v[176:179], a[176:179], v[56:59], v[176:179]
    v_exp_f32 v40, v40
    v_mfma_f32_16x16x32_bf16 v[180:183], a[180:183], v[56:59], v[180:183]
    buffer_load_dwordx4 v20, s[12:15], s24 offen offset:2048  lds
    v_mfma_f32_16x16x32_bf16 v[184:187], a[184:187], v[56:59], v[184:187]
    v_exp_f32 v41, v41
    v_mfma_f32_16x16x32_bf16 v[188:191], a[188:191], v[56:59], v[188:191]
    ds_read_b64_tr_b16 a[144:145], v12 offset:0
    v_cvt_pk_bf16_f32 v54, v40, v41
    v_mfma_f32_16x16x32_bf16 a[216:219], v[24:27], v[56:59], a[216:219]
    buffer_load_dwordx4 v21, s[12:15], s24 offen offset:3072  lds
    v_mfma_f32_16x16x32_bf16 a[32:35], a[192:195], v[56:59], a[32:35]
    v_exp_f32 v42, v42
    v_mfma_f32_16x16x32_bf16 a[36:39], a[196:199], v[56:59], a[36:39]
    ds_read_b64_tr_b16 a[146:147], v12 offset:4096
    ds_read_b64_tr_b16 a[148:149], v13 offset:0
    v_mfma_f32_16x16x32_bf16 a[40:43], a[200:203], v[56:59], a[40:43]
    v_exp_f32 v43, v43
    v_mfma_f32_16x16x32_bf16 a[44:47], a[204:207], v[56:59], a[44:47]
    ds_read_b64_tr_b16 a[150:151], v13 offset:4096
    v_cvt_pk_bf16_f32 v55, v42, v43
    s_waitcnt lgkmcnt(4)
    v_mfma_f32_16x16x32_bf16 v[36:39], a[80:83], v[64:67], 0
    v_exp_f32 v44, v44
    v_mfma_f32_16x16x32_bf16 v[36:39], a[84:87], v[68:71], v[36:39]
    ds_read_b64_tr_b16 a[152:153], v14 offset:0
    ds_read_b64_tr_b16 a[154:155], v14 offset:4096
    v_mfma_f32_16x16x32_bf16 v[36:39], a[88:91], v[72:75], v[36:39]
    v_exp_f32 v45, v45
    v_mfma_f32_16x16x32_bf16 v[36:39], a[92:95], v[76:79], v[36:39]
    v_add_f32 v32, v32, v44
    v_add_f32 v32, v32, v45
    v_mfma_f32_16x16x32_bf16 v[40:43], a[96:99], v[64:67], 0
    v_exp_f32 v46, v46
    v_mfma_f32_16x16x32_bf16 v[40:43], a[100:103], v[68:71], v[40:43]
    v_cvt_pk_bf16_f32 v56, v44, v45
    v_add_f32 v32, v32, v46
    v_mfma_f32_16x16x32_bf16 v[40:43], a[104:107], v[72:75], v[40:43]
    v_exp_f32 v47, v47
    v_mfma_f32_16x16x32_bf16 v[40:43], a[108:111], v[76:79], v[40:43]
    v_add_f32 v32, v32, v47
    v_cvt_pk_bf16_f32 v57, v46, v47
    v_mfma_f32_16x16x32_bf16 v[192:195], a[176:179], v[52:55], v[192:195]
    v_exp_f32 v48, v48
    v_mfma_f32_16x16x32_bf16 v[196:199], a[180:183], v[52:55], v[196:199]
    ds_read_b64_tr_b16 a[156:157], v15 offset:0
    ds_read_b64_tr_b16 a[158:159], v15 offset:4096
    v_mfma_f32_16x16x32_bf16 v[200:203], a[184:187], v[52:55], v[200:203]
    v_exp_f32 v49, v49
    v_mfma_f32_16x16x32_bf16 v[204:207], a[188:191], v[52:55], v[204:207]
    v_add_f32 v32, v32, v48
    v_add_f32 v32, v32, v49
    v_mfma_f32_16x16x32_bf16 a[220:223], v[24:27], v[52:55], a[220:223]
    ds_read_b64_tr_b16 a[160:161], v16 offset:0
    ds_read_b64_tr_b16 a[162:163], v16 offset:4096
    v_mfma_f32_16x16x32_bf16 a[48:51], a[192:195], v[52:55], a[48:51]
    v_exp_f32 v50, v50
    v_mfma_f32_16x16x32_bf16 a[52:55], a[196:199], v[52:55], a[52:55]
    v_cvt_pk_bf16_f32 v58, v48, v49
    v_add_f32 v32, v32, v50
    v_mfma_f32_16x16x32_bf16 a[56:59], a[200:203], v[52:55], a[56:59]
    v_exp_f32 v51, v51
    v_mfma_f32_16x16x32_bf16 a[60:63], a[204:207], v[52:55], a[60:63]
    v_add_f32 v32, v32, v51
    v_cvt_pk_bf16_f32 v59, v50, v51
    v_mfma_f32_16x16x32_bf16 v[44:47], a[80:83], v[80:83], 0
    v_exp_f32 v36, v36
    v_mfma_f32_16x16x32_bf16 v[44:47], a[84:87], v[84:87], v[44:47]
    ds_read_b64_tr_b16 a[164:165], v17 offset:0
    ds_read_b64_tr_b16 a[166:167], v17 offset:4096
    v_mfma_f32_16x16x32_bf16 v[44:47], a[88:91], v[88:91], v[44:47]
    v_exp_f32 v37, v37
    v_mfma_f32_16x16x32_bf16 v[44:47], a[92:95], v[92:95], v[44:47]
    v_add_f32 v28, v28, v36
    v_add_f32 v28, v28, v37
    v_mfma_f32_16x16x32_bf16 v[48:51], a[96:99], v[80:83], 0
    v_exp_f32 v38, v38
    v_mfma_f32_16x16x32_bf16 v[48:51], a[100:103], v[84:87], v[48:51]
    v_cvt_pk_bf16_f32 v52, v36, v37
    v_add_f32 v28, v28, v38
    v_mfma_f32_16x16x32_bf16 v[48:51], a[104:107], v[88:91], v[48:51]
    v_exp_f32 v39, v39
    v_mfma_f32_16x16x32_bf16 v[48:51], a[108:111], v[92:95], v[48:51]
    v_add_f32 v28, v28, v39
    v_cvt_pk_bf16_f32 v53, v38, v39
    v_mfma_f32_16x16x32_bf16 v[208:211], a[176:179], v[56:59], v[208:211]
    v_exp_f32 v40, v40
    v_mfma_f32_16x16x32_bf16 v[212:215], a[180:183], v[56:59], v[212:215]
    ds_read_b64_tr_b16 a[168:169], v18 offset:0
    ds_read_b64_tr_b16 a[170:171], v18 offset:4096
    v_mfma_f32_16x16x32_bf16 v[216:219], a[184:187], v[56:59], v[216:219]
    v_exp_f32 v41, v41
    v_mfma_f32_16x16x32_bf16 v[220:223], a[188:191], v[56:59], v[220:223]
    v_add_f32 v28, v28, v40
    v_add_f32 v28, v28, v41
    v_mfma_f32_16x16x32_bf16 a[64:67], a[192:195], v[56:59], a[64:67]
    v_exp_f32 v42, v42
    v_mfma_f32_16x16x32_bf16 a[68:71], a[196:199], v[56:59], a[68:71]
    v_cvt_pk_bf16_f32 v54, v40, v41
    v_add_f32 v28, v28, v42
    v_mfma_f32_16x16x32_bf16 a[72:75], a[200:203], v[56:59], a[72:75]
    v_exp_f32 v43, v43
    v_mfma_f32_16x16x32_bf16 a[76:79], a[204:207], v[56:59], a[76:79]
    v_add_f32 v28, v28, v43
    v_cvt_pk_bf16_f32 v55, v42, v43
    v_mfma_f32_16x16x32_bf16 v[36:39], a[80:83], v[96:99], 0
    v_exp_f32 v44, v44
    v_mfma_f32_16x16x32_bf16 v[36:39], a[84:87], v[100:103], v[36:39]
    ds_read_b64_tr_b16 a[172:173], v19 offset:0
    ds_read_b64_tr_b16 a[174:175], v19 offset:4096
    v_mfma_f32_16x16x32_bf16 v[36:39], a[88:91], v[104:107], v[36:39]
    v_exp_f32 v45, v45
    v_mfma_f32_16x16x32_bf16 v[36:39], a[92:95], v[108:111], v[36:39]
    v_add_f32 v29, v29, v44
    v_add_f32 v29, v29, v45
    v_mfma_f32_16x16x32_bf16 v[40:43], a[96:99], v[96:99], 0
    v_exp_f32 v46, v46
    v_mfma_f32_16x16x32_bf16 v[40:43], a[100:103], v[100:103], v[40:43]
    v_cvt_pk_bf16_f32 v56, v44, v45
    v_add_f32 v29, v29, v46
    v_mfma_f32_16x16x32_bf16 v[40:43], a[104:107], v[104:107], v[40:43]
    v_exp_f32 v47, v47
    v_mfma_f32_16x16x32_bf16 v[40:43], a[108:111], v[108:111], v[40:43]
    s_waitcnt vmcnt(8) lgkmcnt(0)
    s_barrier
    s_add_u32 s24, s24, 16384
    v_add_f32 v29, v29, v47
    v_cvt_pk_bf16_f32 v57, v46, v47
    v_mfma_f32_16x16x32_bf16 v[144:147], a[144:147], v[52:55], v[144:147]
    s_add_u32 m0, s23, 49152
    v_exp_f32 v48, v48
    v_mfma_f32_16x16x32_bf16 v[148:151], a[148:151], v[52:55], v[148:151]
    buffer_load_dwordx4 v20, s[8:11], s24 offen offset:0  lds
    v_mfma_f32_16x16x32_bf16 v[152:155], a[152:155], v[52:55], v[152:155]
    v_exp_f32 v49, v49
    v_mfma_f32_16x16x32_bf16 v[156:159], a[156:159], v[52:55], v[156:159]
    v_add_f32 v29, v29, v48
    v_add_f32 v29, v29, v49
    v_mfma_f32_16x16x32_bf16 a[0:3], a[160:163], v[52:55], a[0:3]
    v_exp_f32 v50, v50
    v_mfma_f32_16x16x32_bf16 a[4:7], a[164:167], v[52:55], a[4:7]
    v_cvt_pk_bf16_f32 v58, v48, v49
    v_add_f32 v29, v29, v50
    v_mfma_f32_16x16x32_bf16 a[8:11], a[168:171], v[52:55], a[8:11]
    v_exp_f32 v51, v51
    v_mfma_f32_16x16x32_bf16 a[12:15], a[172:175], v[52:55], a[12:15]
    v_add_f32 v29, v29, v51
    v_cvt_pk_bf16_f32 v59, v50, v51
    v_mfma_f32_16x16x32_bf16 v[44:47], a[80:83], v[112:115], 0
    v_exp_f32 v36, v36
    v_mfma_f32_16x16x32_bf16 v[44:47], a[84:87], v[116:119], v[44:47]
    buffer_load_dwordx4 v21, s[8:11], s24 offen offset:1024  lds
    v_mfma_f32_16x16x32_bf16 v[44:47], a[88:91], v[120:123], v[44:47]
    v_exp_f32 v37, v37
    v_mfma_f32_16x16x32_bf16 v[44:47], a[92:95], v[124:127], v[44:47]
    ds_read_b128 a[112:115], v8 offset:16384
    v_cvt_pk_bf16_f32 v52, v36, v37
    v_mfma_f32_16x16x32_bf16 v[48:51], a[96:99], v[112:115], 0
    v_exp_f32 v38, v38
    v_mfma_f32_16x16x32_bf16 v[48:51], a[100:103], v[116:119], v[48:51]
    buffer_load_dwordx4 v20, s[8:11], s24 offen offset:2048  lds
    v_mfma_f32_16x16x32_bf16 v[48:51], a[104:107], v[120:123], v[48:51]
    v_exp_f32 v39, v39
    v_mfma_f32_16x16x32_bf16 v[48:51], a[108:111], v[124:127], v[48:51]
    ds_read_b128 a[116:119], v9 offset:16384
    v_cvt_pk_bf16_f32 v53, v38, v39
    v_mfma_f32_16x16x32_bf16 v[160:163], a[144:147], v[56:59], v[160:163]
    v_exp_f32 v40, v40
    v_mfma_f32_16x16x32_bf16 v[164:167], a[148:151], v[56:59], v[164:167]
    buffer_load_dwordx4 v21, s[8:11], s24 offen offset:3072  lds
    v_mfma_f32_16x16x32_bf16 v[168:171], a[152:155], v[56:59], v[168:171]
    v_exp_f32 v41, v41
    v_mfma_f32_16x16x32_bf16 v[172:175], a[156:159], v[56:59], v[172:175]
    ds_read_b128 a[120:123], v10 offset:16384
    v_cvt_pk_bf16_f32 v54, v40, v41
    v_mfma_f32_16x16x32_bf16 a[16:19], a[160:163], v[56:59], a[16:19]
    v_exp_f32 v42, v42
    v_mfma_f32_16x16x32_bf16 a[20:23], a[164:167], v[56:59], a[20:23]
    ds_read_b128 a[124:127], v11 offset:16384
    ds_read_b128 a[128:131], v8 offset:20480
    v_mfma_f32_16x16x32_bf16 a[24:27], a[168:171], v[56:59], a[24:27]
    v_exp_f32 v43, v43
    v_mfma_f32_16x16x32_bf16 a[28:31], a[172:175], v[56:59], a[28:31]
    ds_read_b128 a[132:135], v9 offset:20480
    v_cvt_pk_bf16_f32 v55, v42, v43
    v_mfma_f32_16x16x32_bf16 v[36:39], a[80:83], v[128:131], 0
    s_add_u32 m0, s23, 114688
    v_exp_f32 v44, v44
    v_mfma_f32_16x16x32_bf16 v[36:39], a[84:87], v[132:135], v[36:39]
    buffer_load_dwordx4 v20, s[12:15], s24 offen offset:0  lds
    v_mfma_f32_16x16x32_bf16 v[36:39], a[88:91], v[136:139], v[36:39]
    v_exp_f32 v45, v45
    v_mfma_f32_16x16x32_bf16 v[36:39], a[92:95], v[140:143], v[36:39]
    ds_read_b128 a[136:139], v10 offset:20480
    v_cvt_pk_bf16_f32 v56, v44, v45
    v_mfma_f32_16x16x32_bf16 v[40:43], a[96:99], v[128:131], 0
    v_exp_f32 v46, v46
    v_mfma_f32_16x16x32_bf16 v[40:43], a[100:103], v[132:135], v[40:43]
    buffer_load_dwordx4 v21, s[12:15], s24 offen offset:1024  lds
    v_mfma_f32_16x16x32_bf16 v[40:43], a[104:107], v[136:139], v[40:43]
    v_exp_f32 v47, v47
    v_mfma_f32_16x16x32_bf16 v[40:43], a[108:111], v[140:143], v[40:43]
    ds_read_b128 a[140:143], v11 offset:20480
    v_cvt_pk_bf16_f32 v57, v46, v47
    v_mfma_f32_16x16x32_bf16 v[176:179], a[144:147], v[52:55], v[176:179]
    v_exp_f32 v48, v48
    v_mfma_f32_16x16x32_bf16 v[180:183], a[148:151], v[52:55], v[180:183]
    buffer_load_dwordx4 v20, s[12:15], s24 offen offset:2048  lds
    v_mfma_f32_16x16x32_bf16 v[184:187], a[152:155], v[52:55], v[184:187]
    v_exp_f32 v49, v49
    v_mfma_f32_16x16x32_bf16 v[188:191], a[156:159], v[52:55], v[188:191]
    ds_read_b64_tr_b16 a[176:177], v12 offset:16384
    v_cvt_pk_bf16_f32 v58, v48, v49
    v_mfma_f32_16x16x32_bf16 a[216:219], v[24:27], v[52:55], a[216:219]
    buffer_load_dwordx4 v21, s[12:15], s24 offen offset:3072  lds
    v_mfma_f32_16x16x32_bf16 a[32:35], a[160:163], v[52:55], a[32:35]
    v_exp_f32 v50, v50
    v_mfma_f32_16x16x32_bf16 a[36:39], a[164:167], v[52:55], a[36:39]
    ds_read_b64_tr_b16 a[178:179], v12 offset:20480
    ds_read_b64_tr_b16 a[180:181], v13 offset:16384
    v_mfma_f32_16x16x32_bf16 a[40:43], a[168:171], v[52:55], a[40:43]
    v_exp_f32 v51, v51
    v_mfma_f32_16x16x32_bf16 a[44:47], a[172:175], v[52:55], a[44:47]
    ds_read_b64_tr_b16 a[182:183], v13 offset:20480
    v_cvt_pk_bf16_f32 v59, v50, v51
    s_waitcnt lgkmcnt(4)
    v_mfma_f32_16x16x32_bf16 v[44:47], a[112:115], v[64:67], 0
    v_exp_f32 v36, v36
    v_mfma_f32_16x16x32_bf16 v[44:47], a[116:119], v[68:71], v[44:47]
    ds_read_b64_tr_b16 a[184:185], v14 offset:16384
    ds_read_b64_tr_b16 a[186:187], v14 offset:20480
    v_mfma_f32_16x16x32_bf16 v[44:47], a[120:123], v[72:75], v[44:47]
    v_exp_f32 v37, v37
    v_mfma_f32_16x16x32_bf16 v[44:47], a[124:127], v[76:79], v[44:47]
    v_add_f32 v32, v32, v36
    v_add_f32 v32, v32, v37
    v_mfma_f32_16x16x32_bf16 v[48:51], a[128:131], v[64:67], 0
    v_exp_f32 v38, v38
    v_mfma_f32_16x16x32_bf16 v[48:51], a[132:135], v[68:71], v[48:51]
    v_cvt_pk_bf16_f32 v52, v36, v37
    v_add_f32 v32, v32, v38
    v_mfma_f32_16x16x32_bf16 v[48:51], a[136:139], v[72:75], v[48:51]
    v_exp_f32 v39, v39
    v_mfma_f32_16x16x32_bf16 v[48:51], a[140:143], v[76:79], v[48:51]
    v_add_f32 v32, v32, v39
    v_cvt_pk_bf16_f32 v53, v38, v39
    v_mfma_f32_16x16x32_bf16 v[192:195], a[144:147], v[56:59], v[192:195]
    v_exp_f32 v40, v40
    v_mfma_f32_16x16x32_bf16 v[196:199], a[148:151], v[56:59], v[196:199]
    ds_read_b64_tr_b16 a[188:189], v15 offset:16384
    ds_read_b64_tr_b16 a[190:191], v15 offset:20480
    v_mfma_f32_16x16x32_bf16 v[200:203], a[152:155], v[56:59], v[200:203]
    v_exp_f32 v41, v41
    v_mfma_f32_16x16x32_bf16 v[204:207], a[156:159], v[56:59], v[204:207]
    v_add_f32 v32, v32, v40
    v_add_f32 v32, v32, v41
    v_mfma_f32_16x16x32_bf16 a[220:223], v[24:27], v[56:59], a[220:223]
    ds_read_b64_tr_b16 a[192:193], v16 offset:16384
    ds_read_b64_tr_b16 a[194:195], v16 offset:20480
    v_mfma_f32_16x16x32_bf16 a[48:51], a[160:163], v[56:59], a[48:51]
    v_exp_f32 v42, v42
    v_mfma_f32_16x16x32_bf16 a[52:55], a[164:167], v[56:59], a[52:55]
    v_cvt_pk_bf16_f32 v54, v40, v41
    v_add_f32 v32, v32, v42
    v_mfma_f32_16x16x32_bf16 a[56:59], a[168:171], v[56:59], a[56:59]
    v_exp_f32 v43, v43
    v_mfma_f32_16x16x32_bf16 a[60:63], a[172:175], v[56:59], a[60:63]
    v_add_f32 v32, v32, v43
    v_cvt_pk_bf16_f32 v55, v42, v43
    v_mfma_f32_16x16x32_bf16 v[36:39], a[112:115], v[80:83], 0
    v_exp_f32 v44, v44
    v_mfma_f32_16x16x32_bf16 v[36:39], a[116:119], v[84:87], v[36:39]
    ds_read_b64_tr_b16 a[196:197], v17 offset:16384
    ds_read_b64_tr_b16 a[198:199], v17 offset:20480
    v_mfma_f32_16x16x32_bf16 v[36:39], a[120:123], v[88:91], v[36:39]
    v_exp_f32 v45, v45
    v_mfma_f32_16x16x32_bf16 v[36:39], a[124:127], v[92:95], v[36:39]
    v_add_f32 v28, v28, v44
    v_add_f32 v28, v28, v45
    v_mfma_f32_16x16x32_bf16 v[40:43], a[128:131], v[80:83], 0
    v_exp_f32 v46, v46
    v_mfma_f32_16x16x32_bf16 v[40:43], a[132:135], v[84:87], v[40:43]
    v_cvt_pk_bf16_f32 v56, v44, v45
    v_add_f32 v28, v28, v46
    v_mfma_f32_16x16x32_bf16 v[40:43], a[136:139], v[88:91], v[40:43]
    v_exp_f32 v47, v47
    v_mfma_f32_16x16x32_bf16 v[40:43], a[140:143], v[92:95], v[40:43]
    v_add_f32 v28, v28, v47
    v_cvt_pk_bf16_f32 v57, v46, v47
    v_mfma_f32_16x16x32_bf16 v[208:211], a[144:147], v[52:55], v[208:211]
    v_exp_f32 v48, v48
    v_mfma_f32_16x16x32_bf16 v[212:215], a[148:151], v[52:55], v[212:215]
    ds_read_b64_tr_b16 a[200:201], v18 offset:16384
    ds_read_b64_tr_b16 a[202:203], v18 offset:20480
    v_mfma_f32_16x16x32_bf16 v[216:219], a[152:155], v[52:55], v[216:219]
    v_exp_f32 v49, v49
    v_mfma_f32_16x16x32_bf16 v[220:223], a[156:159], v[52:55], v[220:223]
    v_add_f32 v28, v28, v48
    v_add_f32 v28, v28, v49
    v_mfma_f32_16x16x32_bf16 a[64:67], a[160:163], v[52:55], a[64:67]
    v_exp_f32 v50, v50
    v_mfma_f32_16x16x32_bf16 a[68:71], a[164:167], v[52:55], a[68:71]
    v_cvt_pk_bf16_f32 v58, v48, v49
    v_add_f32 v28, v28, v50
    v_mfma_f32_16x16x32_bf16 a[72:75], a[168:171], v[52:55], a[72:75]
    v_exp_f32 v51, v51
    v_mfma_f32_16x16x32_bf16 a[76:79], a[172:175], v[52:55], a[76:79]
    v_add_f32 v28, v28, v51
    v_cvt_pk_bf16_f32 v59, v50, v51
    v_mfma_f32_16x16x32_bf16 v[44:47], a[112:115], v[96:99], 0
    v_exp_f32 v36, v36
    v_mfma_f32_16x16x32_bf16 v[44:47], a[116:119], v[100:103], v[44:47]
    ds_read_b64_tr_b16 a[204:205], v19 offset:16384
    ds_read_b64_tr_b16 a[206:207], v19 offset:20480
    v_mfma_f32_16x16x32_bf16 v[44:47], a[120:123], v[104:107], v[44:47]
    v_exp_f32 v37, v37
    v_mfma_f32_16x16x32_bf16 v[44:47], a[124:127], v[108:111], v[44:47]
    v_add_f32 v29, v29, v36
    v_add_f32 v29, v29, v37
    v_mfma_f32_16x16x32_bf16 v[48:51], a[128:131], v[96:99], 0
    v_exp_f32 v38, v38
    v_mfma_f32_16x16x32_bf16 v[48:51], a[132:135], v[100:103], v[48:51]
    v_cvt_pk_bf16_f32 v52, v36, v37
    v_add_f32 v29, v29, v38
    v_mfma_f32_16x16x32_bf16 v[48:51], a[136:139], v[104:107], v[48:51]
    v_exp_f32 v39, v39
    v_mfma_f32_16x16x32_bf16 v[48:51], a[140:143], v[108:111], v[48:51]
    s_waitcnt vmcnt(8) lgkmcnt(0)
    s_barrier
    s_add_u32 s24, s24, 16384
    v_add_f32 v29, v29, v39
    v_cvt_pk_bf16_f32 v53, v38, v39
    v_mfma_f32_16x16x32_bf16 v[144:147], a[176:179], v[56:59], v[144:147]
    s_add_u32 m0, s23, 0
    v_exp_f32 v40, v40
    v_mfma_f32_16x16x32_bf16 v[148:151], a[180:183], v[56:59], v[148:151]
    buffer_load_dwordx4 v20, s[8:11], s24 offen offset:0  lds
    v_mfma_f32_16x16x32_bf16 v[152:155], a[184:187], v[56:59], v[152:155]
    v_exp_f32 v41, v41
    v_mfma_f32_16x16x32_bf16 v[156:159], a[188:191], v[56:59], v[156:159]
    v_add_f32 v29, v29, v40
    v_add_f32 v29, v29, v41
    v_mfma_f32_16x16x32_bf16 a[0:3], a[192:195], v[56:59], a[0:3]
    v_exp_f32 v42, v42
    v_mfma_f32_16x16x32_bf16 a[4:7], a[196:199], v[56:59], a[4:7]
    v_cvt_pk_bf16_f32 v54, v40, v41
    v_add_f32 v29, v29, v42
    v_mfma_f32_16x16x32_bf16 a[8:11], a[200:203], v[56:59], a[8:11]
    v_exp_f32 v43, v43
    v_mfma_f32_16x16x32_bf16 a[12:15], a[204:207], v[56:59], a[12:15]
    v_add_f32 v29, v29, v43
    v_cvt_pk_bf16_f32 v55, v42, v43
    v_mfma_f32_16x16x32_bf16 v[36:39], a[112:115], v[112:115], 0
    v_exp_f32 v44, v44
    v_mfma_f32_16x16x32_bf16 v[36:39], a[116:119], v[116:119], v[36:39]
    buffer_load_dwordx4 v21, s[8:11], s24 offen offset:1024  lds
    v_mfma_f32_16x16x32_bf16 v[36:39], a[120:123], v[120:123], v[36:39]
    v_exp_f32 v45, v45
    v_mfma_f32_16x16x32_bf16 v[36:39], a[124:127], v[124:127], v[36:39]
    ds_read_b128 a[80:83], v8 offset:32768
    v_cvt_pk_bf16_f32 v56, v44, v45
    v_mfma_f32_16x16x32_bf16 v[40:43], a[128:131], v[112:115], 0
    v_exp_f32 v46, v46
    v_mfma_f32_16x16x32_bf16 v[40:43], a[132:135], v[116:119], v[40:43]
    buffer_load_dwordx4 v20, s[8:11], s24 offen offset:2048  lds
    v_mfma_f32_16x16x32_bf16 v[40:43], a[136:139], v[120:123], v[40:43]
    v_exp_f32 v47, v47
    v_mfma_f32_16x16x32_bf16 v[40:43], a[140:143], v[124:127], v[40:43]
    ds_read_b128 a[84:87], v9 offset:32768
    v_cvt_pk_bf16_f32 v57, v46, v47
    v_mfma_f32_16x16x32_bf16 v[160:163], a[176:179], v[52:55], v[160:163]
    v_exp_f32 v48, v48
    v_mfma_f32_16x16x32_bf16 v[164:167], a[180:183], v[52:55], v[164:167]
    buffer_load_dwordx4 v21, s[8:11], s24 offen offset:3072  lds
    v_mfma_f32_16x16x32_bf16 v[168:171], a[184:187], v[52:55], v[168:171]
    v_exp_f32 v49, v49
    v_mfma_f32_16x16x32_bf16 v[172:175], a[188:191], v[52:55], v[172:175]
    ds_read_b128 a[88:91], v10 offset:32768
    v_cvt_pk_bf16_f32 v58, v48, v49
    v_mfma_f32_16x16x32_bf16 a[16:19], a[192:195], v[52:55], a[16:19]
    v_exp_f32 v50, v50
    v_mfma_f32_16x16x32_bf16 a[20:23], a[196:199], v[52:55], a[20:23]
    ds_read_b128 a[92:95], v11 offset:32768
    ds_read_b128 a[96:99], v8 offset:36864
    v_mfma_f32_16x16x32_bf16 a[24:27], a[200:203], v[52:55], a[24:27]
    v_exp_f32 v51, v51
    v_mfma_f32_16x16x32_bf16 a[28:31], a[204:207], v[52:55], a[28:31]
    ds_read_b128 a[100:103], v9 offset:36864
    v_cvt_pk_bf16_f32 v59, v50, v51
    v_mfma_f32_16x16x32_bf16 v[44:47], a[112:115], v[128:131], 0
    s_add_u32 m0, s23, 65536
    v_exp_f32 v36, v36
    v_mfma_f32_16x16x32_bf16 v[44:47], a[116:119], v[132:135], v[44:47]
    buffer_load_dwordx4 v20, s[12:15], s24 offen offset:0  lds
    v_mfma_f32_16x16x32_bf16 v[44:47], a[120:123], v[136:139], v[44:47]
    v_exp_f32 v37, v37
    v_mfma_f32_16x16x32_bf16 v[44:47], a[124:127], v[140:143], v[44:47]
    ds_read_b128 a[104:107], v10 offset:36864
    v_cvt_pk_bf16_f32 v52, v36, v37
    v_mfma_f32_16x16x32_bf16 v[48:51], a[128:131], v[128:131], 0
    v_exp_f32 v38, v38
    v_mfma_f32_16x16x32_bf16 v[48:51], a[132:135], v[132:135], v[48:51]
    buffer_load_dwordx4 v21, s[12:15], s24 offen offset:1024  lds
    v_mfma_f32_16x16x32_bf16 v[48:51], a[136:139], v[136:139], v[48:51]
    v_exp_f32 v39, v39
    v_mfma_f32_16x16x32_bf16 v[48:51], a[140:143], v[140:143], v[48:51]
    ds_read_b128 a[108:111], v11 offset:36864
    v_cvt_pk_bf16_f32 v53, v38, v39
    v_mfma_f32_16x16x32_bf16 v[176:179], a[176:179], v[56:59], v[176:179]
    v_exp_f32 v40, v40
    v_mfma_f32_16x16x32_bf16 v[180:183], a[180:183], v[56:59], v[180:183]
    buffer_load_dwordx4 v20, s[12:15], s24 offen offset:2048  lds
    v_mfma_f32_16x16x32_bf16 v[184:187], a[184:187], v[56:59], v[184:187]
    v_exp_f32 v41, v41
    v_mfma_f32_16x16x32_bf16 v[188:191], a[188:191], v[56:59], v[188:191]
    ds_read_b64_tr_b16 a[144:145], v12 offset:32768
    v_cvt_pk_bf16_f32 v54, v40, v41
    v_mfma_f32_16x16x32_bf16 a[216:219], v[24:27], v[56:59], a[216:219]
    buffer_load_dwordx4 v21, s[12:15], s24 offen offset:3072  lds
    v_mfma_f32_16x16x32_bf16 a[32:35], a[192:195], v[56:59], a[32:35]
    v_exp_f32 v42, v42
    v_mfma_f32_16x16x32_bf16 a[36:39], a[196:199], v[56:59], a[36:39]
    ds_read_b64_tr_b16 a[146:147], v12 offset:36864
    ds_read_b64_tr_b16 a[148:149], v13 offset:32768
    v_mfma_f32_16x16x32_bf16 a[40:43], a[200:203], v[56:59], a[40:43]
    v_exp_f32 v43, v43
    v_mfma_f32_16x16x32_bf16 a[44:47], a[204:207], v[56:59], a[44:47]
    ds_read_b64_tr_b16 a[150:151], v13 offset:36864
    v_cvt_pk_bf16_f32 v55, v42, v43
    s_waitcnt lgkmcnt(4)
    v_mfma_f32_16x16x32_bf16 v[36:39], a[80:83], v[64:67], 0
    v_exp_f32 v44, v44
    v_mfma_f32_16x16x32_bf16 v[36:39], a[84:87], v[68:71], v[36:39]
    ds_read_b64_tr_b16 a[152:153], v14 offset:32768
    ds_read_b64_tr_b16 a[154:155], v14 offset:36864
    v_mfma_f32_16x16x32_bf16 v[36:39], a[88:91], v[72:75], v[36:39]
    v_exp_f32 v45, v45
    v_mfma_f32_16x16x32_bf16 v[36:39], a[92:95], v[76:79], v[36:39]
    v_add_f32 v32, v32, v44
    v_add_f32 v32, v32, v45
    v_mfma_f32_16x16x32_bf16 v[40:43], a[96:99], v[64:67], 0
    v_exp_f32 v46, v46
    v_mfma_f32_16x16x32_bf16 v[40:43], a[100:103], v[68:71], v[40:43]
    v_cvt_pk_bf16_f32 v56, v44, v45
    v_add_f32 v32, v32, v46
    v_mfma_f32_16x16x32_bf16 v[40:43], a[104:107], v[72:75], v[40:43]
    v_exp_f32 v47, v47
    v_mfma_f32_16x16x32_bf16 v[40:43], a[108:111], v[76:79], v[40:43]
    v_add_f32 v32, v32, v47
    v_cvt_pk_bf16_f32 v57, v46, v47
    v_mfma_f32_16x16x32_bf16 v[192:195], a[176:179], v[52:55], v[192:195]
    v_exp_f32 v48, v48
    v_mfma_f32_16x16x32_bf16 v[196:199], a[180:183], v[52:55], v[196:199]
    ds_read_b64_tr_b16 a[156:157], v15 offset:32768
    ds_read_b64_tr_b16 a[158:159], v15 offset:36864
    v_mfma_f32_16x16x32_bf16 v[200:203], a[184:187], v[52:55], v[200:203]
    v_exp_f32 v49, v49
    v_mfma_f32_16x16x32_bf16 v[204:207], a[188:191], v[52:55], v[204:207]
    v_add_f32 v32, v32, v48
    v_add_f32 v32, v32, v49
    v_mfma_f32_16x16x32_bf16 a[220:223], v[24:27], v[52:55], a[220:223]
    ds_read_b64_tr_b16 a[160:161], v16 offset:32768
    ds_read_b64_tr_b16 a[162:163], v16 offset:36864
    v_mfma_f32_16x16x32_bf16 a[48:51], a[192:195], v[52:55], a[48:51]
    v_exp_f32 v50, v50
    v_mfma_f32_16x16x32_bf16 a[52:55], a[196:199], v[52:55], a[52:55]
    v_cvt_pk_bf16_f32 v58, v48, v49
    v_add_f32 v32, v32, v50
    v_mfma_f32_16x16x32_bf16 a[56:59], a[200:203], v[52:55], a[56:59]
    v_exp_f32 v51, v51
    v_mfma_f32_16x16x32_bf16 a[60:63], a[204:207], v[52:55], a[60:63]
    v_add_f32 v32, v32, v51
    v_cvt_pk_bf16_f32 v59, v50, v51
    s_cmp_lt_u32 s24, 262144
    s_cbranch_scc1 L_top
L_tailcode:
    v_mfma_f32_16x16x32_bf16 v[44:47], a[80:83], v[80:83], 0
    v_exp_f32 v36, v36
    v_mfma_f32_16x16x32_bf16 v[44:47], a[84:87], v[84:87], v[44:47]
    ds_read_b64_tr_b16 a[164:165], v17 offset:32768
    ds_read_b64_tr_b16 a[166:167], v17 offset:36864
    v_mfma_f32_16x16x32_bf16 v[44:47], a[88:91], v[88:91], v[44:47]
    v_exp_f32 v37, v37
    v_mfma_f32_16x16x32_bf16 v[44:47], a[92:95], v[92:95], v[44:47]
    v_add_f32 v28, v28, v36
    v_add_f32 v28, v28, v37
    v_mfma_f32_16x16x32_bf16 v[48:51], a[96:99], v[80:83], 0
    v_exp_f32 v38, v38
    v_mfma_f32_16x16x32_bf16 v[48:51], a[100:103], v[84:87], v[48:51]
    v_cvt_pk_bf16_f32 v52, v36, v37
    v_add_f32 v28, v28, v38
    v_mfma_f32_16x16x32_bf16 v[48:51], a[104:107], v[88:91], v[48:51]
    v_exp_f32 v39, v39
    v_mfma_f32_16x16x32_bf16 v[48:51], a[108:111], v[92:95], v[48:51]
    v_add_f32 v28, v28, v39
    v_cvt_pk_bf16_f32 v53, v38, v39
    v_mfma_f32_16x16x32_bf16 v[208:211], a[176:179], v[56:59], v[208:211]
    v_exp_f32 v40, v40
    v_mfma_f32_16x16x32_bf16 v[212:215], a[180:183], v[56:59], v[212:215]
    ds_read_b64_tr_b16 a[168:169], v18 offset:32768
    ds_read_b64_tr_b16 a[170:171], v18 offset:36864
    v_mfma_f32_16x16x32_bf16 v[216:219], a[184:187], v[56:59], v[216:219]
    v_exp_f32 v41, v41
    v_mfma_f32_16x16x32_bf16 v[220:223], a[188:191], v[56:59], v[220:223]
    v_add_f32 v28, v28, v40
    v_add_f32 v28, v28, v41
    v_mfma_f32_16x16x32_bf16 a[64:67], a[192:195], v[56:59], a[64:67]
    v_exp_f32 v42, v42
    v_mfma_f32_16x16x32_bf16 a[68:71], a[196:199], v[56:59], a[68:71]
    v_cvt_pk_bf16_f32 v54, v40, v41
    v_add_f32 v28, v28, v42
    v_mfma_f32_16x16x32_bf16 a[72:75], a[200:203], v[56:59], a[72:75]
    v_exp_f32 v43, v43
    v_mfma_f32_16x16x32_bf16 a[76:79], a[204:207], v[56:59], a[76:79]
    v_add_f32 v28, v28, v43
    v_cvt_pk_bf16_f32 v55, v42, v43
    v_mfma_f32_16x16x32_bf16 v[36:39], a[80:83], v[96:99], 0
    v_exp_f32 v44, v44
    v_mfma_f32_16x16x32_bf16 v[36:39], a[84:87], v[100:103], v[36:39]
    ds_read_b64_tr_b16 a[172:173], v19 offset:32768
    ds_read_b64_tr_b16 a[174:175], v19 offset:36864
    v_mfma_f32_16x16x32_bf16 v[36:39], a[88:91], v[104:107], v[36:39]
    v_exp_f32 v45, v45
    v_mfma_f32_16x16x32_bf16 v[36:39], a[92:95], v[108:111], v[36:39]
    v_add_f32 v29, v29, v44
    v_add_f32 v29, v29, v45
    v_mfma_f32_16x16x32_bf16 v[40:43], a[96:99], v[96:99], 0
    v_exp_f32 v46, v46
    v_mfma_f32_16x16x32_bf16 v[40:43], a[100:103], v[100:103], v[40:43]
    v_cvt_pk_bf16_f32 v56, v44, v45
    v_add_f32 v29, v29, v46
    v_mfma_f32_16x16x32_bf16 v[40:43], a[104:107], v[104:107], v[40:43]
    v_exp_f32 v47, v47
    v_mfma_f32_16x16x32_bf16 v[40:43], a[108:111], v[108:111], v[40:43]
    s_waitcnt vmcnt(8) lgkmcnt(0)
    s_barrier
    v_add_f32 v29, v29, v47
    v_cvt_pk_bf16_f32 v57, v46, v47
    v_mfma_f32_16x16x32_bf16 v[144:147], a[144:147], v[52:55], v[144:147]
    v_exp_f32 v48, v48
    v_mfma_f32_16x16x32_bf16 v[148:151], a[148:151], v[52:55], v[148:151]
    v_mfma_f32_16x16x32_bf16 v[152:155], a[152:155], v[52:55], v[152:155]
    v_exp_f32 v49, v49
    v_mfma_f32_16x16x32_bf16 v[156:159], a[156:159], v[52:55], v[156:159]
    v_add_f32 v29, v29, v48
    v_add_f32 v29, v29, v49
    v_mfma_f32_16x16x32_bf16 a[0:3], a[160:163], v[52:55], a[0:3]
    v_exp_f32 v50, v50
    v_mfma_f32_16x16x32_bf16 a[4:7], a[164:167], v[52:55], a[4:7]
    v_cvt_pk_bf16_f32 v58, v48, v49
    v_add_f32 v29, v29, v50
    v_mfma_f32_16x16x32_bf16 a[8:11], a[168:171], v[52:55], a[8:11]
    v_exp_f32 v51, v51
    v_mfma_f32_16x16x32_bf16 a[12:15], a[172:175], v[52:55], a[12:15]
    v_add_f32 v29, v29, v51
    v_cvt_pk_bf16_f32 v59, v50, v51
    v_mfma_f32_16x16x32_bf16 v[44:47], a[80:83], v[112:115], 0
    v_exp_f32 v36, v36
    v_mfma_f32_16x16x32_bf16 v[44:47], a[84:87], v[116:119], v[44:47]
    v_mfma_f32_16x16x32_bf16 v[44:47], a[88:91], v[120:123], v[44:47]
    v_exp_f32 v37, v37
    v_mfma_f32_16x16x32_bf16 v[44:47], a[92:95], v[124:127], v[44:47]
    ds_read_b128 a[112:115], v8 offset:49152
    v_cvt_pk_bf16_f32 v52, v36, v37
    v_mfma_f32_16x16x32_bf16 v[48:51], a[96:99], v[112:115], 0
    v_exp_f32 v38, v38
    v_mfma_f32_16x16x32_bf16 v[48:51], a[100:103], v[116:119], v[48:51]
    v_mfma_f32_16x16x32_bf16 v[48:51], a[104:107], v[120:123], v[48:51]
    v_exp_f32 v39, v39
    v_mfma_f32_16x16x32_bf16 v[48:51], a[108:111], v[124:127], v[48:51]
    ds_read_b128 a[116:119], v9 offset:49152
    v_cvt_pk_bf16_f32 v53, v38, v39
    v_mfma_f32_16x16x32_bf16 v[160:163], a[144:147], v[56:59], v[160:163]
    v_exp_f32 v40, v40
    v_mfma_f32_16x16x32_bf16 v[164:167], a[148:151], v[56:59], v[164:167]
    v_mfma_f32_16x16x32_bf16 v[168:171], a[152:155], v[56:59], v[168:171]
    v_exp_f32 v41, v41
    v_mfma_f32_16x16x32_bf16 v[172:175], a[156:159], v[56:59], v[172:175]
    ds_read_b128 a[120:123], v10 offset:49152
    v_cvt_pk_bf16_f32 v54, v40, v41
    v_mfma_f32_16x16x32_bf16 a[16:19], a[160:163], v[56:59], a[16:19]
    v_exp_f32 v42, v42
    v_mfma_f32_16x16x32_bf16 a[20:23], a[164:167], v[56:59], a[20:23]
    ds_read_b128 a[124:127], v11 offset:49152
    ds_read_b128 a[128:131], v8 offset:53248
    v_mfma_f32_16x16x32_bf16 a[24:27], a[168:171], v[56:59], a[24:27]
    v_exp_f32 v43, v43
    v_mfma_f32_16x16x32_bf16 a[28:31], a[172:175], v[56:59], a[28:31]
    ds_read_b128 a[132:135], v9 offset:53248
    v_cvt_pk_bf16_f32 v55, v42, v43
    v_mfma_f32_16x16x32_bf16 v[36:39], a[80:83], v[128:131], 0
    v_exp_f32 v44, v44
    v_mfma_f32_16x16x32_bf16 v[36:39], a[84:87], v[132:135], v[36:39]
    v_mfma_f32_16x16x32_bf16 v[36:39], a[88:91], v[136:139], v[36:39]
    v_exp_f32 v45, v45
    v_mfma_f32_16x16x32_bf16 v[36:39], a[92:95], v[140:143], v[36:39]
    ds_read_b128 a[136:139], v10 offset:53248
    v_cvt_pk_bf16_f32 v56, v44, v45
    v_mfma_f32_16x16x32_bf16 v[40:43], a[96:99], v[128:131], 0
    v_exp_f32 v46, v46
    v_mfma_f32_16x16x32_bf16 v[40:43], a[100:103], v[132:135], v[40:43]
    v_mfma_f32_16x16x32_bf16 v[40:43], a[104:107], v[136:139], v[40:43]
    v_exp_f32 v47, v47
    v_mfma_f32_16x16x32_bf16 v[40:43], a[108:111], v[140:143], v[40:43]
    ds_read_b128 a[140:143], v11 offset:53248
    v_cvt_pk_bf16_f32 v57, v46, v47
    v_mfma_f32_16x16x32_bf16 v[176:179], a[144:147], v[52:55], v[176:179]
    v_exp_f32 v48, v48
    v_mfma_f32_16x16x32_bf16 v[180:183], a[148:151], v[52:55], v[180:183]
    v_mfma_f32_16x16x32_bf16 v[184:187], a[152:155], v[52:55], v[184:187]
    v_exp_f32 v49, v49
    v_mfma_f32_16x16x32_bf16 v[188:191], a[156:159], v[52:55], v[188:191]
    ds_read_b64_tr_b16 a[176:177], v12 offset:49152
    v_cvt_pk_bf16_f32 v58, v48, v49
    v_mfma_f32_16x16x32_bf16 a[216:219], v[24:27], v[52:55], a[216:219]
    v_mfma_f32_16x16x32_bf16 a[32:35], a[160:163], v[52:55], a[32:35]
    v_exp_f32 v50, v50
    v_mfma_f32_16x16x32_bf16 a[36:39], a[164:167], v[52:55], a[36:39]
    ds_read_b64_tr_b16 a[178:179], v12 offset:53248
    ds_read_b64_tr_b16 a[180:181], v13 offset:49152
    v_mfma_f32_16x16x32_bf16 a[40:43], a[168:171], v[52:55], a[40:43]
    v_exp_f32 v51, v51
    v_mfma_f32_16x16x32_bf16 a[44:47], a[172:175], v[52:55], a[44:47]
    ds_read_b64_tr_b16 a[182:183], v13 offset:53248
    v_cvt_pk_bf16_f32 v59, v50, v51
    s_waitcnt lgkmcnt(4)
    v_mfma_f32_16x16x32_bf16 v[44:47], a[112:115], v[64:67], 0
    v_exp_f32 v36, v36
    v_mfma_f32_16x16x32_bf16 v[44:47], a[116:119], v[68:71], v[44:47]
    ds_read_b64_tr_b16 a[184:185], v14 offset:49152
    ds_read_b64_tr_b16 a[186:187], v14 offset:53248
    v_mfma_f32_16x16x32_bf16 v[44:47], a[120:123], v[72:75], v[44:47]
    v_exp_f32 v37, v37
    v_mfma_f32_16x16x32_bf16 v[44:47], a[124:127], v[76:79], v[44:47]
    v_add_f32 v32, v32, v36
    v_add_f32 v32, v32, v37
    v_mfma_f32_16x16x32_bf16 v[48:51], a[128:131], v[64:67], 0
    v_exp_f32 v38, v38
    v_mfma_f32_16x16x32_bf16 v[48:51], a[132:135], v[68:71], v[48:51]
    v_cvt_pk_bf16_f32 v52, v36, v37
    v_add_f32 v32, v32, v38
    v_mfma_f32_16x16x32_bf16 v[48:51], a[136:139], v[72:75], v[48:51]
    v_exp_f32 v39, v39
    v_mfma_f32_16x16x32_bf16 v[48:51], a[140:143], v[76:79], v[48:51]
    v_add_f32 v32, v32, v39
    v_cvt_pk_bf16_f32 v53, v38, v39
    v_mfma_f32_16x16x32_bf16 v[192:195], a[144:147], v[56:59], v[192:195]
    v_exp_f32 v40, v40
    v_mfma_f32_16x16x32_bf16 v[196:199], a[148:151], v[56:59], v[196:199]
    ds_read_b64_tr_b16 a[188:189], v15 offset:49152
    ds_read_b64_tr_b16 a[190:191], v15 offset:53248
    v_mfma_f32_16x16x32_bf16 v[200:203], a[152:155], v[56:59], v[200:203]
    v_exp_f32 v41, v41
    v_mfma_f32_16x16x32_bf16 v[204:207], a[156:159], v[56:59], v[204:207]
    v_add_f32 v32, v32, v40
    v_add_f32 v32, v32, v41
    v_mfma_f32_16x16x32_bf16 a[220:223], v[24:27], v[56:59], a[220:223]
    ds_read_b64_tr_b16 a[192:193], v16 offset:49152
    ds_read_b64_tr_b16 a[194:195], v16 offset:53248
    v_mfma_f32_16x16x32_bf16 a[48:51], a[160:163], v[56:59], a[48:51]
    v_exp_f32 v42, v42
    v_mfma_f32_16x16x32_bf16 a[52:55], a[164:167], v[56:59], a[52:55]
    v_cvt_pk_bf16_f32 v54, v40, v41
    v_add_f32 v32, v32, v42
    v_mfma_f32_16x16x32_bf16 a[56:59], a[168:171], v[56:59], a[56:59]
    v_exp_f32 v43, v43
    v_mfma_f32_16x16x32_bf16 a[60:63], a[172:175], v[56:59], a[60:63]
    v_add_f32 v32, v32, v43
    v_cvt_pk_bf16_f32 v55, v42, v43
    v_mfma_f32_16x16x32_bf16 v[36:39], a[112:115], v[80:83], 0
    v_exp_f32 v44, v44
    v_mfma_f32_16x16x32_bf16 v[36:39], a[116:119], v[84:87], v[36:39]
    ds_read_b64_tr_b16 a[196:197], v17 offset:49152
    ds_read_b64_tr_b16 a[198:199], v17 offset:53248
    v_mfma_f32_16x16x32_bf16 v[36:39], a[120:123], v[88:91], v[36:39]
    v_exp_f32 v45, v45
    v_mfma_f32_16x16x32_bf16 v[36:39], a[124:127], v[92:95], v[36:39]
    v_add_f32 v28, v28, v44
    v_add_f32 v28, v28, v45
    v_mfma_f32_16x16x32_bf16 v[40:43], a[128:131], v[80:83], 0
    v_exp_f32 v46, v46
    v_mfma_f32_16x16x32_bf16 v[40:43], a[132:135], v[84:87], v[40:43]
    v_cvt_pk_bf16_f32 v56, v44, v45
    v_add_f32 v28, v28, v46
    v_mfma_f32_16x16x32_bf16 v[40:43], a[136:139], v[88:91], v[40:43]
    v_exp_f32 v47, v47
    v_mfma_f32_16x16x32_bf16 v[40:43], a[140:143], v[92:95], v[40:43]
    v_add_f32 v28, v28, v47
    v_cvt_pk_bf16_f32 v57, v46, v47
    v_mfma_f32_16x16x32_bf16 v[208:211], a[144:147], v[52:55], v[208:211]
    v_exp_f32 v48, v48
    v_mfma_f32_16x16x32_bf16 v[212:215], a[148:151], v[52:55], v[212:215]
    ds_read_b64_tr_b16 a[200:201], v18 offset:49152
    ds_read_b64_tr_b16 a[202:203], v18 offset:53248
    v_mfma_f32_16x16x32_bf16 v[216:219], a[152:155], v[52:55], v[216:219]
    v_exp_f32 v49, v49
    v_mfma_f32_16x16x32_bf16 v[220:223], a[156:159], v[52:55], v[220:223]
    v_add_f32 v28, v28, v48
    v_add_f32 v28, v28, v49
    v_mfma_f32_16x16x32_bf16 a[64:67], a[160:163], v[52:55], a[64:67]
    v_exp_f32 v50, v50
    v_mfma_f32_16x16x32_bf16 a[68:71], a[164:167], v[52:55], a[68:71]
    v_cvt_pk_bf16_f32 v58, v48, v49
    v_add_f32 v28, v28, v50
    v_mfma_f32_16x16x32_bf16 a[72:75], a[168:171], v[52:55], a[72:75]
    v_exp_f32 v51, v51
    v_mfma_f32_16x16x32_bf16 a[76:79], a[172:175], v[52:55], a[76:79]
    v_add_f32 v28, v28, v51
    v_cvt_pk_bf16_f32 v59, v50, v51
    v_mfma_f32_16x16x32_bf16 v[44:47], a[112:115], v[96:99], 0
    v_exp_f32 v36, v36
    v_mfma_f32_16x16x32_bf16 v[44:47], a[116:119], v[100:103], v[44:47]
    ds_read_b64_tr_b16 a[204:205], v19 offset:49152
    ds_read_b64_tr_b16 a[206:207], v19 offset:53248
    v_mfma_f32_16x16x32_bf16 v[44:47], a[120:123], v[104:107], v[44:47]
    v_exp_f32 v37, v37
    v_mfma_f32_16x16x32_bf16 v[44:47], a[124:127], v[108:111], v[44:47]
    v_add_f32 v29, v29, v36
    v_add_f32 v29, v29, v37
    v_mfma_f32_16x16x32_bf16 v[48:51], a[128:131], v[96:99], 0
    v_exp_f32 v38, v38
    v_mfma_f32_16x16x32_bf16 v[48:51], a[132:135], v[100:103], v[48:51]
    v_cvt_pk_bf16_f32 v52, v36, v37
    v_add_f32 v29, v29, v38
    v_mfma_f32_16x16x32_bf16 v[48:51], a[136:139], v[104:107], v[48:51]
    v_exp_f32 v39, v39
    v_mfma_f32_16x16x32_bf16 v[48:51], a[140:143], v[108:111], v[48:51]
    s_waitcnt vmcnt(0) lgkmcnt(0)
    s_barrier
    v_add_f32 v29, v29, v39
    v_cvt_pk_bf16_f32 v53, v38, v39
    v_mfma_f32_16x16x32_bf16 a[0:3], a[192:195], v[56:59], a[0:3]
    v_exp_f32 v40, v40
    v_mfma_f32_16x16x32_bf16 a[4:7], a[196:199], v[56:59], a[4:7]
    v_mfma_f32_16x16x32_bf16 a[8:11], a[200:203], v[56:59], a[8:11]
    v_exp_f32 v41, v41
    v_mfma_f32_16x16x32_bf16 a[12:15], a[204:207], v[56:59], a[12:15]
    v_add_f32 v29, v29, v40
    v_add_f32 v29, v29, v41
    v_mfma_f32_16x16x32_bf16 v[144:147], a[176:179], v[56:59], v[144:147]
    v_exp_f32 v42, v42
    v_mfma_f32_16x16x32_bf16 v[148:151], a[180:183], v[56:59], v[148:151]
    v_cvt_pk_bf16_f32 v54, v40, v41
    v_add_f32 v29, v29, v42
    v_mfma_f32_16x16x32_bf16 v[152:155], a[184:187], v[56:59], v[152:155]
    v_exp_f32 v43, v43
    v_mfma_f32_16x16x32_bf16 v[156:159], a[188:191], v[56:59], v[156:159]
    v_add_f32 v29, v29, v43
    v_cvt_pk_bf16_f32 v55, v42, v43
    v_mfma_f32_16x16x32_bf16 v[36:39], a[112:115], v[112:115], 0
    v_exp_f32 v44, v44
    v_mfma_f32_16x16x32_bf16 v[36:39], a[116:119], v[116:119], v[36:39]
    ds_write_b128 v34, a[0:3] offset:0
    v_mfma_f32_16x16x32_bf16 v[36:39], a[120:123], v[120:123], v[36:39]
    v_exp_f32 v45, v45
    v_mfma_f32_16x16x32_bf16 v[36:39], a[124:127], v[124:127], v[36:39]
    v_cvt_pk_bf16_f32 v56, v44, v45
    v_mfma_f32_16x16x32_bf16 v[40:43], a[128:131], v[112:115], 0
    v_exp_f32 v46, v46
    v_mfma_f32_16x16x32_bf16 v[40:43], a[132:135], v[116:119], v[40:43]
    ds_write_b128 v34, a[4:7] offset:1024
    v_mfma_f32_16x16x32_bf16 v[40:43], a[136:139], v[120:123], v[40:43]
    v_exp_f32 v47, v47
    v_mfma_f32_16x16x32_bf16 v[40:43], a[140:143], v[124:127], v[40:43]
    v_cvt_pk_bf16_f32 v57, v46, v47
    v_mfma_f32_16x16x32_bf16 a[16:19], a[192:195], v[52:55], a[16:19]
    v_exp_f32 v48, v48
    v_mfma_f32_16x16x32_bf16 a[20:23], a[196:199], v[52:55], a[20:23]
    ds_write_b128 v34, a[8:11] offset:2048
    v_mfma_f32_16x16x32_bf16 a[24:27], a[200:203], v[52:55], a[24:27]
    v_exp_f32 v49, v49
    v_mfma_f32_16x16x32_bf16 a[28:31], a[204:207], v[52:55], a[28:31]
    v_cvt_pk_bf16_f32 v58, v48, v49
    v_mfma_f32_16x16x32_bf16 v[160:163], a[176:179], v[52:55], v[160:163]
    v_exp_f32 v50, v50
    v_mfma_f32_16x16x32_bf16 v[164:167], a[180:183], v[52:55], v[164:167]
    ds_write_b128 v34, a[12:15] offset:3072
    v_mfma_f32_16x16x32_bf16 v[168:171], a[184:187], v[52:55], v[168:171]
    v_exp_f32 v51, v51
    v_mfma_f32_16x16x32_bf16 v[172:175], a[188:191], v[52:55], v[172:175]
    v_cvt_pk_bf16_f32 v59, v50, v51
    v_mfma_f32_16x16x32_bf16 v[44:47], a[112:115], v[128:131], 0
    v_exp_f32 v36, v36
    v_mfma_f32_16x16x32_bf16 v[44:47], a[116:119], v[132:135], v[44:47]
    ds_write_b128 v34, a[16:19] offset:4096
    v_mfma_f32_16x16x32_bf16 v[44:47], a[120:123], v[136:139], v[44:47]
    v_exp_f32 v37, v37
    v_mfma_f32_16x16x32_bf16 v[44:47], a[124:127], v[140:143], v[44:47]
    v_cvt_pk_bf16_f32 v52, v36, v37
    v_mfma_f32_16x16x32_bf16 v[48:51], a[128:131], v[128:131], 0
    v_exp_f32 v38, v38
    v_mfma_f32_16x16x32_bf16 v[48:51], a[132:135], v[132:135], v[48:51]
    ds_write_b128 v34, a[20:23] offset:5120
    v_mfma_f32_16x16x32_bf16 v[48:51], a[136:139], v[136:139], v[48:51]
    v_exp_f32 v39, v39
    v_mfma_f32_16x16x32_bf16 v[48:51], a[140:143], v[140:143], v[48:51]
    v_cvt_pk_bf16_f32 v53, v38, v39
    v_mfma_f32_16x16x32_bf16 a[32:35], a[192:195], v[56:59], a[32:35]
    v_exp_f32 v40, v40
    v_mfma_f32_16x16x32_bf16 a[36:39], a[196:199], v[56:59], a[36:39]
    ds_write_b128 v34, a[24:27] offset:6144
    v_mfma_f32_16x16x32_bf16 a[40:43], a[200:203], v[56:59], a[40:43]
    v_exp_f32 v41, v41
    v_mfma_f32_16x16x32_bf16 a[44:47], a[204:207], v[56:59], a[44:47]
    v_cvt_pk_bf16_f32 v54, v40, v41
    v_mfma_f32_16x16x32_bf16 a[216:219], v[24:27], v[56:59], a[216:219]
    ds_write_b128 v34, a[28:31] offset:7168
    v_mfma_f32_16x16x32_bf16 v[176:179], a[176:179], v[56:59], v[176:179]
    v_exp_f32 v42, v42
    v_mfma_f32_16x16x32_bf16 v[180:183], a[180:183], v[56:59], v[180:183]
    v_mfma_f32_16x16x32_bf16 v[184:187], a[184:187], v[56:59], v[184:187]
    v_exp_f32 v43, v43
    v_mfma_f32_16x16x32_bf16 v[188:191], a[188:191], v[56:59], v[188:191]
    v_cvt_pk_bf16_f32 v55, v42, v43
    ds_write_b32 v60, v28 offset:0
    ds_write_b32 v60, v29 offset:512
    s_waitcnt lgkmcnt(0)
    s_barrier
    ds_read_b128 v[234:237], v61 offset:0
    ds_read_b128 v[238:241], v22 offset:0
    ds_read_b128 v[64:67], v35 offset:0
    ds_read_b128 v[68:71], v35 offset:1024
    ds_read_b128 v[72:75], v35 offset:2048
    ds_read_b128 v[76:79], v35 offset:3072
    ds_read_b128 v[0:3], v61 offset:512
    ds_read_b128 v[4:7], v22 offset:512
    ds_read_b128 v[80:83], v35 offset:4096
    ds_read_b128 v[84:87], v35 offset:5120
    ds_read_b128 v[88:91], v35 offset:6144
    ds_read_b128 v[92:95], v35 offset:7168
    v_mfma_f32_16x16x32_bf16 a[48:51], a[192:195], v[52:55], a[48:51]
    v_exp_f32 v44, v44
    v_mfma_f32_16x16x32_bf16 a[52:55], a[196:199], v[52:55], a[52:55]
    ds_write_b128 v34, a[32:35] offset:8192
    v_exp_f32 v45, v45
    v_add_f32 v32, v32, v44
    v_mfma_f32_16x16x32_bf16 a[56:59], a[200:203], v[52:55], a[56:59]
    v_exp_f32 v46, v46
    v_add_f32 v32, v32, v45
    v_cvt_pk_bf16_f32 v56, v44, v45
    v_mfma_f32_16x16x32_bf16 a[60:63], a[204:207], v[52:55], a[60:63]
    ds_write_b128 v34, a[36:39] offset:9216
    v_exp_f32 v47, v47
    v_add_f32 v32, v32, v46
    v_mfma_f32_16x16x32_bf16 a[220:223], v[24:27], v[52:55], a[220:223]
    v_exp_f32 v48, v48
    v_add_f32 v32, v32, v47
    v_cvt_pk_bf16_f32 v57, v46, v47
    v_mfma_f32_16x16x32_bf16 v[192:195], a[176:179], v[52:55], v[192:195]
    ds_write_b128 v34, a[40:43] offset:10240
    v_exp_f32 v49, v49
    v_add_f32 v32, v32, v48
    v_mfma_f32_16x16x32_bf16 v[196:199], a[180:183], v[52:55], v[196:199]
    v_exp_f32 v50, v50
    v_add_f32 v32, v32, v49
    v_cvt_pk_bf16_f32 v58, v48, v49
    v_mfma_f32_16x16x32_bf16 v[200:203], a[184:187], v[52:55], v[200:203]
    ds_write_b128 v34, a[44:47] offset:11264
    v_exp_f32 v51, v51
    v_add_f32 v32, v32, v50
    v_mfma_f32_16x16x32_bf16 v[204:207], a[188:191], v[52:55], v[204:207]
    s_nop 0
    v_add_f32 v32, v32, v51
    v_cvt_pk_bf16_f32 v59, v50, v51
    s_waitcnt lgkmcnt(10)
    v_pk_add_f32 v[234:235], v[234:235], v[236:237]
    v_pk_add_f32 v[238:239], v[238:239], v[240:241]
    v_pk_add_f32 v[144:145], v[144:145], v[64:65]
    v_pk_add_f32 v[234:235], v[234:235], v[238:239]
    v_pk_add_f32 v[146:147], v[146:147], v[66:67]
    v_add_f32 v28, v234, v235
    v_pk_add_f32 v[148:149], v[148:149], v[68:69]
    v_rcp_f32 v224, v28
    v_pk_add_f32 v[150:151], v[150:151], v[70:71]
    v_pk_add_f32 v[152:153], v[152:153], v[72:73]
    v_pk_add_f32 v[154:155], v[154:155], v[74:75]
    v_pk_add_f32 v[156:157], v[156:157], v[76:77]
    v_pk_add_f32 v[158:159], v[158:159], v[78:79]
    v_pk_mul_f32 v[144:145], v[144:145], v[224:225] op_sel_hi:[1,0]
    v_pk_mul_f32 v[146:147], v[146:147], v[224:225] op_sel_hi:[1,0]
    v_cvt_pk_bf16_f32 v144, v144, v145
    v_cvt_pk_bf16_f32 v145, v146, v147
    v_pk_mul_f32 v[148:149], v[148:149], v[224:225] op_sel_hi:[1,0]
    v_pk_mul_f32 v[150:151], v[150:151], v[224:225] op_sel_hi:[1,0]
    ds_write_b64 v244, v[144:145] offset:0
    v_cvt_pk_bf16_f32 v148, v148, v149
    v_cvt_pk_bf16_f32 v149, v150, v151
    v_pk_mul_f32 v[152:153], v[152:153], v[224:225] op_sel_hi:[1,0]
    v_pk_mul_f32 v[154:155], v[154:155], v[224:225] op_sel_hi:[1,0]
    ds_write_b64 v245, v[148:149] offset:0
    v_cvt_pk_bf16_f32 v152, v152, v153
    v_cvt_pk_bf16_f32 v153, v154, v155
    v_pk_mul_f32 v[156:157], v[156:157], v[224:225] op_sel_hi:[1,0]
    v_pk_mul_f32 v[158:159], v[158:159], v[224:225] op_sel_hi:[1,0]
    ds_write_b64 v246, v[152:153] offset:0
    v_cvt_pk_bf16_f32 v156, v156, v157
    v_cvt_pk_bf16_f32 v157, v158, v159
    ds_write_b64 v247, v[156:157] offset:0
    ds_read_b128 v[36:39], v248 offset:0
    ds_read_b64 v[40:41], v248 offset:1032
    ds_read_b64 v[42:43], v248 offset:1024
    v_mfma_f32_16x16x32_bf16 a[64:67], a[192:195], v[56:59], a[64:67]
    ds_write_b128 v34, a[48:51] offset:12288
    v_mfma_f32_16x16x32_bf16 a[68:71], a[196:199], v[56:59], a[68:71]
    v_mfma_f32_16x16x32_bf16 a[72:75], a[200:203], v[56:59], a[72:75]
    ds_write_b128 v34, a[52:55] offset:13312
    v_mfma_f32_16x16x32_bf16 a[76:79], a[204:207], v[56:59], a[76:79]
    s_mov_b32 s54, 0
    s_mov_b32 s55, 2048
    s_waitcnt lgkmcnt(2)
    buffer_store_dwordx4 v[36:39], v249, s[16:19], s54 offen sc1 nt
    buffer_store_dwordx4 v[40:43], v249, s[16:19], s55 offen sc1 nt
    v_mfma_f32_16x16x32_bf16 v[208:211], a[176:179], v[56:59], v[208:211]
    ds_write_b128 v34, a[56:59] offset:14336
    v_mfma_f32_16x16x32_bf16 v[212:215], a[180:183], v[56:59], v[212:215]
    v_mfma_f32_16x16x32_bf16 v[216:219], a[184:187], v[56:59], v[216:219]
    ds_write_b128 v34, a[60:63] offset:15360
    v_mfma_f32_16x16x32_bf16 v[220:223], a[188:191], v[56:59], v[220:223]
    v_accvgpr_read_b32 v30, a216
    ds_write_b32 v60, v30 offset:1024
    v_accvgpr_read_b32 v31, a220
    ds_write_b32 v60, v31 offset:1536
    ds_write_b32 v60, v32 offset:2048
    s_nop 1
    ds_write_b128 v34, a[64:67] offset:16384
    ds_write_b128 v34, a[68:71] offset:17408
    ds_write_b128 v34, a[72:75] offset:18432
    ds_write_b128 v34, a[76:79] offset:19456
    s_waitcnt lgkmcnt(0)
    s_barrier
    ds_read_b128 v[234:237], v61 offset:1024
    ds_read_b128 v[238:241], v22 offset:1024
    ds_read_b128 v[96:99], v35 offset:8192
    ds_read_b128 v[100:103], v35 offset:9216
    ds_read_b128 v[104:107], v35 offset:10240
    ds_read_b128 v[108:111], v35 offset:11264
    s_waitcnt lgkmcnt(15)
    v_pk_add_f32 v[0:1], v[0:1], v[2:3]
    v_pk_add_f32 v[4:5], v[4:5], v[6:7]
    ds_read_b128 v[112:115], v35 offset:12288
    v_pk_add_f32 v[160:161], v[160:161], v[80:81]
    v_pk_add_f32 v[0:1], v[0:1], v[4:5]
    ds_read_b128 v[116:119], v35 offset:13312
    v_pk_add_f32 v[162:163], v[162:163], v[82:83]
    v_add_f32 v29, v0, v1
    ds_read_b128 v[120:123], v35 offset:14336
    v_pk_add_f32 v[164:165], v[164:165], v[84:85]
    v_rcp_f32 v226, v29
    ds_read_b128 v[124:127], v35 offset:15360
    v_pk_add_f32 v[166:167], v[166:167], v[86:87]
    v_pk_add_f32 v[168:169], v[168:169], v[88:89]
    v_pk_add_f32 v[170:171], v[170:171], v[90:91]
    v_pk_add_f32 v[172:173], v[172:173], v[92:93]
    v_pk_add_f32 v[174:175], v[174:175], v[94:95]
    v_pk_mul_f32 v[160:161], v[160:161], v[226:227] op_sel_hi:[1,0]
    v_pk_mul_f32 v[162:163], v[162:163], v[226:227] op_sel_hi:[1,0]
    v_cvt_pk_bf16_f32 v160, v160, v161
    v_cvt_pk_bf16_f32 v161, v162, v163
    v_pk_mul_f32 v[164:165], v[164:165], v[226:227] op_sel_hi:[1,0]
    v_pk_mul_f32 v[166:167], v[166:167], v[226:227] op_sel_hi:[1,0]
    ds_write_b64 v244, v[160:161] offset:2048
    v_cvt_pk_bf16_f32 v164, v164, v165
    v_cvt_pk_bf16_f32 v165, v166, v167
    v_pk_mul_f32 v[168:169], v[168:169], v[226:227] op_sel_hi:[1,0]
    v_pk_mul_f32 v[170:171], v[170:171], v[226:227] op_sel_hi:[1,0]
    ds_write_b64 v245, v[164:165] offset:2048
    v_cvt_pk_bf16_f32 v168, v168, v169
    v_cvt_pk_bf16_f32 v169, v170, v171
    v_pk_mul_f32 v[172:173], v[172:173], v[226:227] op_sel_hi:[1,0]
    v_pk_mul_f32 v[174:175], v[174:175], v[226:227] op_sel_hi:[1,0]
    ds_write_b64 v246, v[168:169] offset:2048
    v_cvt_pk_bf16_f32 v172, v172, v173
    v_cvt_pk_bf16_f32 v173, v174, v175
    ds_write_b64 v247, v[172:173] offset:2048
    ds_read_b128 v[44:47], v248 offset:2048
    ds_read_b64 v[48:49], v248 offset:3080
    ds_read_b64 v[50:51], v248 offset:3072
    s_waitcnt lgkmcnt(11)
    v_pk_add_f32 v[234:235], v[234:235], v[236:237]
    v_pk_add_f32 v[238:239], v[238:239], v[240:241]
    ds_read_b128 v[0:3], v61 offset:1536
    v_pk_add_f32 v[176:177], v[176:177], v[96:97]
    v_pk_add_f32 v[234:235], v[234:235], v[238:239]
    ds_read_b128 v[4:7], v22 offset:1536
    v_pk_add_f32 v[178:179], v[178:179], v[98:99]
    v_add_f32 v30, v234, v235
    ds_read_b128 v[128:131], v35 offset:16384
    v_pk_add_f32 v[180:181], v[180:181], v[100:101]
    v_rcp_f32 v228, v30
    ds_read_b128 v[132:135], v35 offset:17408
    v_pk_add_f32 v[182:183], v[182:183], v[102:103]
    v_pk_add_f32 v[184:185], v[184:185], v[104:105]
    ds_read_b128 v[136:139], v35 offset:18432
    v_pk_add_f32 v[186:187], v[186:187], v[106:107]
    v_pk_add_f32 v[188:189], v[188:189], v[108:109]
    ds_read_b128 v[140:143], v35 offset:19456
    v_pk_add_f32 v[190:191], v[190:191], v[110:111]
    v_pk_mul_f32 v[176:177], v[176:177], v[228:229] op_sel_hi:[1,0]
    v_pk_mul_f32 v[178:179], v[178:179], v[228:229] op_sel_hi:[1,0]
    v_cvt_pk_bf16_f32 v176, v176, v177
    v_cvt_pk_bf16_f32 v177, v178, v179
    v_pk_mul_f32 v[180:181], v[180:181], v[228:229] op_sel_hi:[1,0]
    v_pk_mul_f32 v[182:183], v[182:183], v[228:229] op_sel_hi:[1,0]
    ds_write_b64 v244, v[176:177] offset:4096
    v_cvt_pk_bf16_f32 v180, v180, v181
    v_cvt_pk_bf16_f32 v181, v182, v183
    v_pk_mul_f32 v[184:185], v[184:185], v[228:229] op_sel_hi:[1,0]
    v_pk_mul_f32 v[186:187], v[186:187], v[228:229] op_sel_hi:[1,0]
    ds_write_b64 v245, v[180:181] offset:4096
    v_cvt_pk_bf16_f32 v184, v184, v185
    v_cvt_pk_bf16_f32 v185, v186, v187
    v_pk_mul_f32 v[188:189], v[188:189], v[228:229] op_sel_hi:[1,0]
    v_pk_mul_f32 v[190:191], v[190:191], v[228:229] op_sel_hi:[1,0]
    ds_write_b64 v246, v[184:185] offset:4096
    v_cvt_pk_bf16_f32 v188, v188, v189
    v_cvt_pk_bf16_f32 v189, v190, v191
    ds_write_b64 v247, v[188:189] offset:4096
    ds_read_b128 v[36:39], v248 offset:4096
    ds_read_b64 v[40:41], v248 offset:5128
    ds_read_b64 v[42:43], v248 offset:5120
    s_mov_b32 s54, 4096
    s_mov_b32 s55, 6144
    s_waitcnt lgkmcnt(13)
    buffer_store_dwordx4 v[44:47], v249, s[16:19], s54 offen sc1 nt
    buffer_store_dwordx4 v[48:51], v249, s[16:19], s55 offen sc1 nt
    s_waitcnt lgkmcnt(11)
    v_pk_add_f32 v[0:1], v[0:1], v[2:3]
    v_pk_add_f32 v[4:5], v[4:5], v[6:7]
    ds_read_b128 v[234:237], v61 offset:2048
    v_pk_add_f32 v[192:193], v[192:193], v[112:113]
    v_pk_add_f32 v[0:1], v[0:1], v[4:5]
    ds_read_b128 v[238:241], v22 offset:2048
    v_pk_add_f32 v[194:195], v[194:195], v[114:115]
    v_add_f32 v31, v0, v1
    v_pk_add_f32 v[196:197], v[196:197], v[116:117]
    v_rcp_f32 v230, v31
    v_pk_add_f32 v[198:199], v[198:199], v[118:119]
    v_pk_add_f32 v[200:201], v[200:201], v[120:121]
    v_pk_add_f32 v[202:203], v[202:203], v[122:123]
    v_pk_add_f32 v[204:205], v[204:205], v[124:125]
    v_pk_add_f32 v[206:207], v[206:207], v[126:127]
    v_pk_mul_f32 v[192:193], v[192:193], v[230:231] op_sel_hi:[1,0]
    v_pk_mul_f32 v[194:195], v[194:195], v[230:231] op_sel_hi:[1,0]
    v_cvt_pk_bf16_f32 v192, v192, v193
    v_cvt_pk_bf16_f32 v193, v194, v195
    v_pk_mul_f32 v[196:197], v[196:197], v[230:231] op_sel_hi:[1,0]
    v_pk_mul_f32 v[198:199], v[198:199], v[230:231] op_sel_hi:[1,0]
    ds_write_b64 v244, v[192:193] offset:6144
    v_cvt_pk_bf16_f32 v196, v196, v197
    v_cvt_pk_bf16_f32 v197, v198, v199
    v_pk_mul_f32 v[200:201], v[200:201], v[230:231] op_sel_hi:[1,0]
    v_pk_mul_f32 v[202:203], v[202:203], v[230:231] op_sel_hi:[1,0]
    ds_write_b64 v245, v[196:197] offset:6144
    v_cvt_pk_bf16_f32 v200, v200, v201
    v_cvt_pk_bf16_f32 v201, v202, v203
    v_pk_mul_f32 v[204:205], v[204:205], v[230:231] op_sel_hi:[1,0]
    v_pk_mul_f32 v[206:207], v[206:207], v[230:231] op_sel_hi:[1,0]
    ds_write_b64 v246, v[200:201] offset:6144
    v_cvt_pk_bf16_f32 v204, v204, v205
    v_cvt_pk_bf16_f32 v205, v206, v207
    ds_write_b64 v247, v[204:205] offset:6144
    ds_read_b128 v[44:47], v248 offset:6144
    ds_read_b64 v[48:49], v248 offset:7176
    ds_read_b64 v[50:51], v248 offset:7168
    s_mov_b32 s54, 8192
    s_mov_b32 s55, 10240
    s_waitcnt lgkmcnt(9)
    buffer_store_dwordx4 v[36:39], v249, s[16:19], s54 offen sc1 nt
    buffer_store_dwordx4 v[40:43], v249, s[16:19], s55 offen sc1 nt
    s_waitcnt lgkmcnt(7)
    v_pk_add_f32 v[234:235], v[234:235], v[236:237]
    v_pk_add_f32 v[238:239], v[238:239], v[240:241]
    v_pk_add_f32 v[208:209], v[208:209], v[128:129]
    v_pk_add_f32 v[234:235], v[234:235], v[238:239]
    v_pk_add_f32 v[210:211], v[210:211], v[130:131]
    v_add_f32 v32, v234, v235
    v_pk_add_f32 v[212:213], v[212:213], v[132:133]
    v_rcp_f32 v232, v32
    v_pk_add_f32 v[214:215], v[214:215], v[134:135]
    v_pk_add_f32 v[216:217], v[216:217], v[136:137]
    v_pk_add_f32 v[218:219], v[218:219], v[138:139]
    v_pk_add_f32 v[220:221], v[220:221], v[140:141]
    v_pk_add_f32 v[222:223], v[222:223], v[142:143]
    v_pk_mul_f32 v[208:209], v[208:209], v[232:233] op_sel_hi:[1,0]
    v_pk_mul_f32 v[210:211], v[210:211], v[232:233] op_sel_hi:[1,0]
    v_cvt_pk_bf16_f32 v208, v208, v209
    v_cvt_pk_bf16_f32 v209, v210, v211
    v_pk_mul_f32 v[212:213], v[212:213], v[232:233] op_sel_hi:[1,0]
    v_pk_mul_f32 v[214:215], v[214:215], v[232:233] op_sel_hi:[1,0]
    ds_write_b64 v244, v[208:209] offset:8192
    v_cvt_pk_bf16_f32 v212, v212, v213
    v_cvt_pk_bf16_f32 v213, v214, v215
    v_pk_mul_f32 v[216:217], v[216:217], v[232:233] op_sel_hi:[1,0]
    v_pk_mul_f32 v[218:219], v[218:219], v[232:233] op_sel_hi:[1,0]
    ds_write_b64 v245, v[212:213] offset:8192
    v_cvt_pk_bf16_f32 v216, v216, v217
    v_cvt_pk_bf16_f32 v217, v218, v219
    v_pk_mul_f32 v[220:221], v[220:221], v[232:233] op_sel_hi:[1,0]
    v_pk_mul_f32 v[222:223], v[222:223], v[232:233] op_sel_hi:[1,0]
    ds_write_b64 v246, v[216:217] offset:8192
    v_cvt_pk_bf16_f32 v220, v220, v221
    v_cvt_pk_bf16_f32 v221, v222, v223
    ds_write_b64 v247, v[220:221] offset:8192
    ds_read_b128 v[36:39], v248 offset:8192
    ds_read_b64 v[40:41], v248 offset:9224
    ds_read_b64 v[42:43], v248 offset:9216
    s_mov_b32 s54, 12288
    s_mov_b32 s55, 14336
    s_waitcnt lgkmcnt(7)
    buffer_store_dwordx4 v[44:47], v249, s[16:19], s54 offen sc1 nt
    buffer_store_dwordx4 v[48:51], v249, s[16:19], s55 offen sc1 nt
    s_mov_b32 s54, 16384
    s_mov_b32 s55, 18432
    s_waitcnt lgkmcnt(0)
    buffer_store_dwordx4 v[36:39], v249, s[16:19], s54 offen sc1 nt
    buffer_store_dwordx4 v[40:43], v249, s[16:19], s55 offen sc1 nt
    s_mov_b32 s52, 0x3c800000
    s_mov_b32 s53, 0x71800000
    s_mov_b64 s[56:57], 0
    v_cmp_nle_f32 vcc, s52, v28
    s_or_b64 s[56:57], s[56:57], vcc
    v_cmp_nge_f32 vcc, s53, v28
    s_or_b64 s[56:57], s[56:57], vcc
    v_cmp_nle_f32 vcc, s52, v29
    s_or_b64 s[56:57], s[56:57], vcc
    v_cmp_nge_f32 vcc, s53, v29
    s_or_b64 s[56:57], s[56:57], vcc
    v_cmp_nle_f32 vcc, s52, v30
    s_or_b64 s[56:57], s[56:57], vcc
    v_cmp_nge_f32 vcc, s53, v30
    s_or_b64 s[56:57], s[56:57], vcc
    v_cmp_nle_f32 vcc, s52, v31
    s_or_b64 s[56:57], s[56:57], vcc
    v_cmp_nge_f32 vcc, s53, v31
    s_or_b64 s[56:57], s[56:57], vcc
    v_cmp_nle_f32 vcc, s52, v32
    s_or_b64 s[56:57], s[56:57], vcc
    v_cmp_nge_f32 vcc, s53, v32
    s_or_b64 s[56:57], s[56:57], vcc
    v_mov_b32 v1, 0
    v_mov_b32 v2, 0
    v_mov_b32 v3, 0
    v_dot2_f32_bf16 v1, v144, v3, v1
    v_dot2_f32_bf16 v2, v145, v3, v2
    v_dot2_f32_bf16 v1, v148, v3, v1
    v_dot2_f32_bf16 v2, v149, v3, v2
    v_dot2_f32_bf16 v1, v152, v3, v1
    v_dot2_f32_bf16 v2, v153, v3, v2
    v_dot2_f32_bf16 v1, v156, v3, v1
    v_dot2_f32_bf16 v2, v157, v3, v2
    v_dot2_f32_bf16 v1, v160, v3, v1
    v_dot2_f32_bf16 v2, v161, v3, v2
    v_dot2_f32_bf16 v1, v164, v3, v1
    v_dot2_f32_bf16 v2, v165, v3, v2
    v_dot2_f32_bf16 v1, v168, v3, v1
    v_dot2_f32_bf16 v2, v169, v3, v2
    v_dot2_f32_bf16 v1, v172, v3, v1
    v_dot2_f32_bf16 v2, v173, v3, v2
    v_dot2_f32_bf16 v1, v176, v3, v1
    v_dot2_f32_bf16 v2, v177, v3, v2
    v_dot2_f32_bf16 v1, v180, v3, v1
    v_dot2_f32_bf16 v2, v181, v3, v2
    v_dot2_f32_bf16 v1, v184, v3, v1
    v_dot2_f32_bf16 v2, v185, v3, v2
    v_dot2_f32_bf16 v1, v188, v3, v1
    v_dot2_f32_bf16 v2, v189, v3, v2
    v_dot2_f32_bf16 v1, v192, v3, v1
    v_dot2_f32_bf16 v2, v193, v3, v2
    v_dot2_f32_bf16 v1, v196, v3, v1
    v_dot2_f32_bf16 v2, v197, v3, v2
    v_dot2_f32_bf16 v1, v200, v3, v1
    v_dot2_f32_bf16 v2, v201, v3, v2
    v_dot2_f32_bf16 v1, v204, v3, v1
    v_dot2_f32_bf16 v2, v205, v3, v2
    v_dot2_f32_bf16 v1, v208, v3, v1
    v_dot2_f32_bf16 v2, v209, v3, v2
    v_dot2_f32_bf16 v1, v212, v3, v1
    v_dot2_f32_bf16 v2, v213, v3, v2
    v_dot2_f32_bf16 v1, v216, v3, v1
    v_dot2_f32_bf16 v2, v217, v3, v2
    v_dot2_f32_bf16 v1, v220, v3, v1
    v_dot2_f32_bf16 v2, v221, v3, v2
    s_nop 3
    v_add_f32 v1, v1, v2
    s_nop 0
    v_cmp_neq_f32 vcc, 0, v1
    s_or_b64 s[56:57], s[56:57], vcc
    s_cmp_lg_u64 s[56:57], 0
    s_cselect_b32 s58, 1, 0
    s_lshl_b32 s59, s20, 2
    s_add_u32 s59, s59, 147456
    v_mov_b32 v1, s59
    v_mov_b32 v2, s58
    ds_write_b32 v1, v2
    s_waitcnt lgkmcnt(0)
    s_barrier
    v_mov_b32 v1, 147456
    ds_read_b128 v[4:7], v1
    s_waitcnt lgkmcnt(0)
    v_or_b32 v4, v4, v5
    v_or_b32 v6, v6, v7
    v_or_b32 v4, v4, v6
    s_nop 1
    v_readfirstlane_b32 s58, v4
    s_nop 3
    s_cmp_eq_u32 s58, 0
    s_cbranch_scc1 L_end
    s_waitcnt vmcnt(0)
    s_barrier
    s_branch L_slow
L_end:
    s_endpgm
L_slow:
    s_mov_b32 s26, 1
    s_add_u32 s50, s27, 0
    s_add_u32 m0, s50, 122880
    s_nop 0
    buffer_load_dwordx4 v20, s[4:7], s50 offen offset:0  lds
    buffer_load_dwordx4 v21, s[4:7], s50 offen offset:1024  lds
    s_add_u32 s50, s27, 4096
    s_add_u32 m0, s50, 122880
    s_nop 0
    buffer_load_dwordx4 v20, s[4:7], s50 offen offset:0  lds
    buffer_load_dwordx4 v21, s[4:7], s50 offen offset:1024  lds
    s_add_u32 s50, s27, 8192
    s_add_u32 m0, s50, 122880
    s_nop 0
    buffer_load_dwordx4 v20, s[4:7], s50 offen offset:0  lds
    buffer_load_dwordx4 v21, s[4:7], s50 offen offset:1024  lds
    s_add_u32 s50, s27, 12288
    s_add_u32 m0, s50, 122880
    s_nop 0
    buffer_load_dwordx4 v20, s[4:7], s50 offen offset:0  lds
    buffer_load_dwordx4 v21, s[4:7], s50 offen offset:1024  lds
    s_add_u32 s50, s27, 16384
    s_add_u32 m0, s50, 122880
    s_nop 0
    buffer_load_dwordx4 v20, s[4:7], s50 offen offset:0  lds
    buffer_load_dwordx4 v21, s[4:7], s50 offen offset:1024  lds
    v_and_b32 v2, 15, v33
    v_lshrrev_b32 v3, 4, v33
    s_lshl_b32 s48, s22, 5
    v_and_b32 v4, 7, v2
    v_lshlrev_b32 v4, 1, v4
    v_add_u32 v5, s48, v2
    v_lshlrev_b32 v5, 8, v5
    v_add_u32 v6, 0, v3
    v_xor_b32 v6, v6, v4
    v_lshl_add_u32 v8, v6, 4, v5
    v_add_u32 v6, 4, v3
    v_xor_b32 v6, v6, v4
    v_lshl_add_u32 v9, v6, 4, v5
    v_add_u32 v6, 8, v3
    v_xor_b32 v6, v6, v4
    v_lshl_add_u32 v10, v6, 4, v5
    v_add_u32 v6, 12, v3
    v_xor_b32 v6, v6, v4
    v_lshl_add_u32 v11, v6, 4, v5
    v_lshrrev_b32 v4, 2, v2
    v_and_b32 v5, 1, v3
    v_lshl_add_u32 v5, v5, 2, v4
    s_lshl_b32 s49, s22, 2
    v_xor_b32 v5, s49, v5
    v_lshl_add_u32 v6, v3, 2, v4
    v_add_u32 v6, s48, v6
    v_lshlrev_b32 v6, 8, v6
    v_and_b32 v7, 3, v2
    v_lshl_add_u32 v6, v7, 3, v6
    v_add_u32 v6, 65536, v6
    v_xor_b32 v7, 0, v5
    v_lshl_add_u32 v12, v7, 5, v6
    v_xor_b32 v7, 1, v5
    v_lshl_add_u32 v13, v7, 5, v6
    v_xor_b32 v7, 2, v5
    v_lshl_add_u32 v14, v7, 5, v6
    v_xor_b32 v7, 3, v5
    v_lshl_add_u32 v15, v7, 5, v6
    v_xor_b32 v7, 4, v5
    v_lshl_add_u32 v16, v7, 5, v6
    v_xor_b32 v7, 5, v5
    v_lshl_add_u32 v17, v7, 5, v6
    v_xor_b32 v7, 6, v5
    v_lshl_add_u32 v18, v7, 5, v6
    v_xor_b32 v7, 7, v5
    v_lshl_add_u32 v19, v7, 5, v6
    v_cmp_eq_u32 vcc, 0, v2
    v_mov_b32 v4, 0x3f803f80
    s_nop 0
    v_cndmask_b32 v24, 0, v4, vcc
    v_mov_b32 v25, v24
    v_mov_b32 v26, v24
    v_mov_b32 v27, v24
    s_mul_i32 s48, s21, 20480
    s_lshl_b32 s49, s22, 13
    s_sub_u32 s48, s48, s49
    s_add_u32 s48, s48, 122880
    v_add_u32 v240, s48, v8
    v_add_u32 v241, s48, v9
    v_add_u32 v242, s48, v10
    v_add_u32 v243, s48, v11
    s_mov_b32 s56, 0x3e0293ee
    s_mov_b32 s57, 0x3e0293ee
    s_mov_b32 s58, 0xffff0000
    s_waitcnt vmcnt(0)
    s_barrier
    ds_read_b128 v[64:67], v240 offset:0
    ds_read_b128 v[68:71], v241 offset:0
    ds_read_b128 v[72:75], v242 offset:0
    ds_read_b128 v[76:79], v243 offset:0
    s_waitcnt lgkmcnt(0)
    v_lshlrev_b32 v224, 16, v64
    v_and_b32 v225, s58, v64
    v_lshlrev_b32 v226, 16, v65
    v_and_b32 v227, s58, v65
    v_lshlrev_b32 v228, 16, v66
    v_and_b32 v229, s58, v66
    v_lshlrev_b32 v230, 16, v67
    v_and_b32 v231, s58, v67
    v_pk_mul_f32 v[224:225], v[224:225], s[56:57]
    v_pk_mul_f32 v[226:227], v[226:227], s[56:57]
    v_pk_mul_f32 v[228:229], v[228:229], s[56:57]
    v_pk_mul_f32 v[230:231], v[230:231], s[56:57]
    v_cvt_pk_bf16_f32 v64, v224, v225
    v_cvt_pk_bf16_f32 v65, v226, v227
    v_cvt_pk_bf16_f32 v66, v228, v229
    v_cvt_pk_bf16_f32 v67, v230, v231
    v_lshlrev_b32 v224, 16, v68
    v_and_b32 v225, s58, v68
    v_lshlrev_b32 v226, 16, v69
    v_and_b32 v227, s58, v69
    v_lshlrev_b32 v228, 16, v70
    v_and_b32 v229, s58, v70
    v_lshlrev_b32 v230, 16, v71
    v_and_b32 v231, s58, v71
    v_pk_mul_f32 v[224:225], v[224:225], s[56:57]
    v_pk_mul_f32 v[226:227], v[226:227], s[56:57]
    v_pk_mul_f32 v[228:229], v[228:229], s[56:57]
    v_pk_mul_f32 v[230:231], v[230:231], s[56:57]
    v_cvt_pk_bf16_f32 v68, v224, v225
    v_cvt_pk_bf16_f32 v69, v226, v227
    v_cvt_pk_bf16_f32 v70, v228, v229
    v_cvt_pk_bf16_f32 v71, v230, v231
    v_lshlrev_b32 v224, 16, v72
    v_and_b32 v225, s58, v72
    v_lshlrev_b32 v226, 16, v73
    v_and_b32 v227, s58, v73
    v_lshlrev_b32 v228, 16, v74
    v_and_b32 v229, s58, v74
    v_lshlrev_b32 v230, 16, v75
    v_and_b32 v231, s58, v75
    v_pk_mul_f32 v[224:225], v[224:225], s[56:57]
    v_pk_mul_f32 v[226:227], v[226:227], s[56:57]
    v_pk_mul_f32 v[228:229], v[228:229], s[56:57]
    v_pk_mul_f32 v[230:231], v[230:231], s[56:57]
    v_cvt_pk_bf16_f32 v72, v224, v225
    v_cvt_pk_bf16_f32 v73, v226, v227
    v_cvt_pk_bf16_f32 v74, v228, v229
    v_cvt_pk_bf16_f32 v75, v230, v231
    v_lshlrev_b32 v224, 16, v76
    v_and_b32 v225, s58, v76
    v_lshlrev_b32 v226, 16, v77
    v_and_b32 v227, s58, v77
    v_lshlrev_b32 v228, 16, v78
    v_and_b32 v229, s58, v78
    v_lshlrev_b32 v230, 16, v79
    v_and_b32 v231, s58, v79
    v_pk_mul_f32 v[224:225], v[224:225], s[56:57]
    v_pk_mul_f32 v[226:227], v[226:227], s[56:57]
    v_pk_mul_f32 v[228:229], v[228:229], s[56:57]
    v_pk_mul_f32 v[230:231], v[230:231], s[56:57]
    v_cvt_pk_bf16_f32 v76, v224, v225
    v_cvt_pk_bf16_f32 v77, v226, v227
    v_cvt_pk_bf16_f32 v78, v228, v229
    v_cvt_pk_bf16_f32 v79, v230, v231
    ds_read_b128 v[80:83], v240 offset:4096
    ds_read_b128 v[84:87], v241 offset:4096
    ds_read_b128 v[88:91], v242 offset:4096
    ds_read_b128 v[92:95], v243 offset:4096
    s_waitcnt lgkmcnt(0)
    v_lshlrev_b32 v224, 16, v80
    v_and_b32 v225, s58, v80
    v_lshlrev_b32 v226, 16, v81
    v_and_b32 v227, s58, v81
    v_lshlrev_b32 v228, 16, v82
    v_and_b32 v229, s58, v82
    v_lshlrev_b32 v230, 16, v83
    v_and_b32 v231, s58, v83
    v_pk_mul_f32 v[224:225], v[224:225], s[56:57]
    v_pk_mul_f32 v[226:227], v[226:227], s[56:57]
    v_pk_mul_f32 v[228:229], v[228:229], s[56:57]
    v_pk_mul_f32 v[230:231], v[230:231], s[56:57]
    v_cvt_pk_bf16_f32 v80, v224, v225
    v_cvt_pk_bf16_f32 v81, v226, v227
    v_cvt_pk_bf16_f32 v82, v228, v229
    v_cvt_pk_bf16_f32 v83, v230, v231
    v_lshlrev_b32 v224, 16, v84
    v_and_b32 v225, s58, v84
    v_lshlrev_b32 v226, 16, v85
    v_and_b32 v227, s58, v85
    v_lshlrev_b32 v228, 16, v86
    v_and_b32 v229, s58, v86
    v_lshlrev_b32 v230, 16, v87
    v_and_b32 v231, s58, v87
    v_pk_mul_f32 v[224:225], v[224:225], s[56:57]
    v_pk_mul_f32 v[226:227], v[226:227], s[56:57]
    v_pk_mul_f32 v[228:229], v[228:229], s[56:57]
    v_pk_mul_f32 v[230:231], v[230:231], s[56:57]
    v_cvt_pk_bf16_f32 v84, v224, v225
    v_cvt_pk_bf16_f32 v85, v226, v227
    v_cvt_pk_bf16_f32 v86, v228, v229
    v_cvt_pk_bf16_f32 v87, v230, v231
    v_lshlrev_b32 v224, 16, v88
    v_and_b32 v225, s58, v88
    v_lshlrev_b32 v226, 16, v89
    v_and_b32 v227, s58, v89
    v_lshlrev_b32 v228, 16, v90
    v_and_b32 v229, s58, v90
    v_lshlrev_b32 v230, 16, v91
    v_and_b32 v231, s58, v91
    v_pk_mul_f32 v[224:225], v[224:225], s[56:57]
    v_pk_mul_f32 v[226:227], v[226:227], s[56:57]
    v_pk_mul_f32 v[228:229], v[228:229], s[56:57]
    v_pk_mul_f32 v[230:231], v[230:231], s[56:57]
    v_cvt_pk_bf16_f32 v88, v224, v225
    v_cvt_pk_bf16_f32 v89, v226, v227
    v_cvt_pk_bf16_f32 v90, v228, v229
    v_cvt_pk_bf16_f32 v91, v230, v231
    v_lshlrev_b32 v224, 16, v92
    v_and_b32 v225, s58, v92
    v_lshlrev_b32 v226, 16, v93
    v_and_b32 v227, s58, v93
    v_lshlrev_b32 v228, 16, v94
    v_and_b32 v229, s58, v94
    v_lshlrev_b32 v230, 16, v95
    v_and_b32 v231, s58, v95
    v_pk_mul_f32 v[224:225], v[224:225], s[56:57]
    v_pk_mul_f32 v[226:227], v[226:227], s[56:57]
    v_pk_mul_f32 v[228:229], v[228:229], s[56:57]
    v_pk_mul_f32 v[230:231], v[230:231], s[56:57]
    v_cvt_pk_bf16_f32 v92, v224, v225
    v_cvt_pk_bf16_f32 v93, v226, v227
    v_cvt_pk_bf16_f32 v94, v228, v229
    v_cvt_pk_bf16_f32 v95, v230, v231
    ds_read_b128 v[96:99], v240 offset:8192
    ds_read_b128 v[100:103], v241 offset:8192
    ds_read_b128 v[104:107], v242 offset:8192
    ds_read_b128 v[108:111], v243 offset:8192
    s_waitcnt lgkmcnt(0)
    v_lshlrev_b32 v224, 16, v96
    v_and_b32 v225, s58, v96
    v_lshlrev_b32 v226, 16, v97
    v_and_b32 v227, s58, v97
    v_lshlrev_b32 v228, 16, v98
    v_and_b32 v229, s58, v98
    v_lshlrev_b32 v230, 16, v99
    v_and_b32 v231, s58, v99
    v_pk_mul_f32 v[224:225], v[224:225], s[56:57]
    v_pk_mul_f32 v[226:227], v[226:227], s[56:57]
    v_pk_mul_f32 v[228:229], v[228:229], s[56:57]
    v_pk_mul_f32 v[230:231], v[230:231], s[56:57]
    v_cvt_pk_bf16_f32 v96, v224, v225
    v_cvt_pk_bf16_f32 v97, v226, v227
    v_cvt_pk_bf16_f32 v98, v228, v229
    v_cvt_pk_bf16_f32 v99, v230, v231
    v_lshlrev_b32 v224, 16, v100
    v_and_b32 v225, s58, v100
    v_lshlrev_b32 v226, 16, v101
    v_and_b32 v227, s58, v101
    v_lshlrev_b32 v228, 16, v102
    v_and_b32 v229, s58, v102
    v_lshlrev_b32 v230, 16, v103
    v_and_b32 v231, s58, v103
    v_pk_mul_f32 v[224:225], v[224:225], s[56:57]
    v_pk_mul_f32 v[226:227], v[226:227], s[56:57]
    v_pk_mul_f32 v[228:229], v[228:229], s[56:57]
    v_pk_mul_f32 v[230:231], v[230:231], s[56:57]
    v_cvt_pk_bf16_f32 v100, v224, v225
    v_cvt_pk_bf16_f32 v101, v226, v227
    v_cvt_pk_bf16_f32 v102, v228, v229
    v_cvt_pk_bf16_f32 v103, v230, v231
    v_lshlrev_b32 v224, 16, v104
    v_and_b32 v225, s58, v104
    v_lshlrev_b32 v226, 16, v105
    v_and_b32 v227, s58, v105
    v_lshlrev_b32 v228, 16, v106
    v_and_b32 v229, s58, v106
    v_lshlrev_b32 v230, 16, v107
    v_and_b32 v231, s58, v107
    v_pk_mul_f32 v[224:225], v[224:225], s[56:57]
    v_pk_mul_f32 v[226:227], v[226:227], s[56:57]
    v_pk_mul_f32 v[228:229], v[228:229], s[56:57]
    v_pk_mul_f32 v[230:231], v[230:231], s[56:57]
    v_cvt_pk_bf16_f32 v104, v224, v225
    v_cvt_pk_bf16_f32 v105, v226, v227
    v_cvt_pk_bf16_f32 v106, v228, v229
    v_cvt_pk_bf16_f32 v107, v230, v231
    v_lshlrev_b32 v224, 16, v108
    v_and_b32 v225, s58, v108
    v_lshlrev_b32 v226, 16, v109
    v_and_b32 v227, s58, v109
    v_lshlrev_b32 v228, 16, v110
    v_and_b32 v229, s58, v110
    v_lshlrev_b32 v230, 16, v111
    v_and_b32 v231, s58, v111
    v_pk_mul_f32 v[224:225], v[224:225], s[56:57]
    v_pk_mul_f32 v[226:227], v[226:227], s[56:57]
    v_pk_mul_f32 v[228:229], v[228:229], s[56:57]
    v_pk_mul_f32 v[230:231], v[230:231], s[56:57]
    v_cvt_pk_bf16_f32 v108, v224, v225
    v_cvt_pk_bf16_f32 v109, v226, v227
    v_cvt_pk_bf16_f32 v110, v228, v229
    v_cvt_pk_bf16_f32 v111, v230, v231
    ds_read_b128 v[112:115], v240 offset:12288
    ds_read_b128 v[116:119], v241 offset:12288
    ds_read_b128 v[120:123], v242 offset:12288
    ds_read_b128 v[124:127], v243 offset:12288
    s_waitcnt lgkmcnt(0)
    v_lshlrev_b32 v224, 16, v112
    v_and_b32 v225, s58, v112
    v_lshlrev_b32 v226, 16, v113
    v_and_b32 v227, s58, v113
    v_lshlrev_b32 v228, 16, v114
    v_and_b32 v229, s58, v114
    v_lshlrev_b32 v230, 16, v115
    v_and_b32 v231, s58, v115
    v_pk_mul_f32 v[224:225], v[224:225], s[56:57]
    v_pk_mul_f32 v[226:227], v[226:227], s[56:57]
    v_pk_mul_f32 v[228:229], v[228:229], s[56:57]
    v_pk_mul_f32 v[230:231], v[230:231], s[56:57]
    v_cvt_pk_bf16_f32 v112, v224, v225
    v_cvt_pk_bf16_f32 v113, v226, v227
    v_cvt_pk_bf16_f32 v114, v228, v229
    v_cvt_pk_bf16_f32 v115, v230, v231
    v_lshlrev_b32 v224, 16, v116
    v_and_b32 v225, s58, v116
    v_lshlrev_b32 v226, 16, v117
    v_and_b32 v227, s58, v117
    v_lshlrev_b32 v228, 16, v118
    v_and_b32 v229, s58, v118
    v_lshlrev_b32 v230, 16, v119
    v_and_b32 v231, s58, v119
    v_pk_mul_f32 v[224:225], v[224:225], s[56:57]
    v_pk_mul_f32 v[226:227], v[226:227], s[56:57]
    v_pk_mul_f32 v[228:229], v[228:229], s[56:57]
    v_pk_mul_f32 v[230:231], v[230:231], s[56:57]
    v_cvt_pk_bf16_f32 v116, v224, v225
    v_cvt_pk_bf16_f32 v117, v226, v227
    v_cvt_pk_bf16_f32 v118, v228, v229
    v_cvt_pk_bf16_f32 v119, v230, v231
    v_lshlrev_b32 v224, 16, v120
    v_and_b32 v225, s58, v120
    v_lshlrev_b32 v226, 16, v121
    v_and_b32 v227, s58, v121
    v_lshlrev_b32 v228, 16, v122
    v_and_b32 v229, s58, v122
    v_lshlrev_b32 v230, 16, v123
    v_and_b32 v231, s58, v123
    v_pk_mul_f32 v[224:225], v[224:225], s[56:57]
    v_pk_mul_f32 v[226:227], v[226:227], s[56:57]
    v_pk_mul_f32 v[228:229], v[228:229], s[56:57]
    v_pk_mul_f32 v[230:231], v[230:231], s[56:57]
    v_cvt_pk_bf16_f32 v120, v224, v225
    v_cvt_pk_bf16_f32 v121, v226, v227
    v_cvt_pk_bf16_f32 v122, v228, v229
    v_cvt_pk_bf16_f32 v123, v230, v231
    v_lshlrev_b32 v224, 16, v124
    v_and_b32 v225, s58, v124
    v_lshlrev_b32 v226, 16, v125
    v_and_b32 v227, s58, v125
    v_lshlrev_b32 v228, 16, v126
    v_and_b32 v229, s58, v126
    v_lshlrev_b32 v230, 16, v127
    v_and_b32 v231, s58, v127
    v_pk_mul_f32 v[224:225], v[224:225], s[56:57]
    v_pk_mul_f32 v[226:227], v[226:227], s[56:57]
    v_pk_mul_f32 v[228:229], v[228:229], s[56:57]
    v_pk_mul_f32 v[230:231], v[230:231], s[56:57]
    v_cvt_pk_bf16_f32 v124, v224, v225
    v_cvt_pk_bf16_f32 v125, v226, v227
    v_cvt_pk_bf16_f32 v126, v228, v229
    v_cvt_pk_bf16_f32 v127, v230, v231
    ds_read_b128 v[128:131], v240 offset:16384
    ds_read_b128 v[132:135], v241 offset:16384
    ds_read_b128 v[136:139], v242 offset:16384
    ds_read_b128 v[140:143], v243 offset:16384
    s_waitcnt lgkmcnt(0)
    v_lshlrev_b32 v224, 16, v128
    v_and_b32 v225, s58, v128
    v_lshlrev_b32 v226, 16, v129
    v_and_b32 v227, s58, v129
    v_lshlrev_b32 v228, 16, v130
    v_and_b32 v229, s58, v130
    v_lshlrev_b32 v230, 16, v131
    v_and_b32 v231, s58, v131
    v_pk_mul_f32 v[224:225], v[224:225], s[56:57]
    v_pk_mul_f32 v[226:227], v[226:227], s[56:57]
    v_pk_mul_f32 v[228:229], v[228:229], s[56:57]
    v_pk_mul_f32 v[230:231], v[230:231], s[56:57]
    v_cvt_pk_bf16_f32 v128, v224, v225
    v_cvt_pk_bf16_f32 v129, v226, v227
    v_cvt_pk_bf16_f32 v130, v228, v229
    v_cvt_pk_bf16_f32 v131, v230, v231
    v_lshlrev_b32 v224, 16, v132
    v_and_b32 v225, s58, v132
    v_lshlrev_b32 v226, 16, v133
    v_and_b32 v227, s58, v133
    v_lshlrev_b32 v228, 16, v134
    v_and_b32 v229, s58, v134
    v_lshlrev_b32 v230, 16, v135
    v_and_b32 v231, s58, v135
    v_pk_mul_f32 v[224:225], v[224:225], s[56:57]
    v_pk_mul_f32 v[226:227], v[226:227], s[56:57]
    v_pk_mul_f32 v[228:229], v[228:229], s[56:57]
    v_pk_mul_f32 v[230:231], v[230:231], s[56:57]
    v_cvt_pk_bf16_f32 v132, v224, v225
    v_cvt_pk_bf16_f32 v133, v226, v227
    v_cvt_pk_bf16_f32 v134, v228, v229
    v_cvt_pk_bf16_f32 v135, v230, v231
    v_lshlrev_b32 v224, 16, v136
    v_and_b32 v225, s58, v136
    v_lshlrev_b32 v226, 16, v137
    v_and_b32 v227, s58, v137
    v_lshlrev_b32 v228, 16, v138
    v_and_b32 v229, s58, v138
    v_lshlrev_b32 v230, 16, v139
    v_and_b32 v231, s58, v139
    v_pk_mul_f32 v[224:225], v[224:225], s[56:57]
    v_pk_mul_f32 v[226:227], v[226:227], s[56:57]
    v_pk_mul_f32 v[228:229], v[228:229], s[56:57]
    v_pk_mul_f32 v[230:231], v[230:231], s[56:57]
    v_cvt_pk_bf16_f32 v136, v224, v225
    v_cvt_pk_bf16_f32 v137, v226, v227
    v_cvt_pk_bf16_f32 v138, v228, v229
    v_cvt_pk_bf16_f32 v139, v230, v231
    v_lshlrev_b32 v224, 16, v140
    v_and_b32 v225, s58, v140
    v_lshlrev_b32 v226, 16, v141
    v_and_b32 v227, s58, v141
    v_lshlrev_b32 v228, 16, v142
    v_and_b32 v229, s58, v142
    v_lshlrev_b32 v230, 16, v143
    v_and_b32 v231, s58, v143
    v_pk_mul_f32 v[224:225], v[224:225], s[56:57]
    v_pk_mul_f32 v[226:227], v[226:227], s[56:57]
    v_pk_mul_f32 v[228:229], v[228:229], s[56:57]
    v_pk_mul_f32 v[230:231], v[230:231], s[56:57]
    v_cvt_pk_bf16_f32 v140, v224, v225
    v_cvt_pk_bf16_f32 v141, v226, v227
    v_cvt_pk_bf16_f32 v142, v228, v229
    v_cvt_pk_bf16_f32 v143, v230, v231
    v_mov_b32 v252, 0xff800000
    v_mov_b32 v253, 0xff800000
    v_mov_b32 v254, 0xff800000
    v_mov_b32 v255, 0xff800000
    v_mov_b32 v34, 0xff800000
    s_mov_b32 s24, s23
L_smax:
    s_barrier
    s_add_u32 m0, s23, 0
    s_nop 0
    buffer_load_dwordx4 v20, s[8:11], s24 offen offset:0  lds
    buffer_load_dwordx4 v21, s[8:11], s24 offen offset:1024  lds
    buffer_load_dwordx4 v20, s[8:11], s24 offen offset:2048  lds
    buffer_load_dwordx4 v21, s[8:11], s24 offen offset:3072  lds
    s_waitcnt vmcnt(0)
    s_barrier
    ds_read_b128 a[80:83], v8 offset:0
    ds_read_b128 a[84:87], v9 offset:0
    ds_read_b128 a[88:91], v10 offset:0
    ds_read_b128 a[92:95], v11 offset:0
    ds_read_b128 a[96:99], v8 offset:4096
    ds_read_b128 a[100:103], v9 offset:4096
    ds_read_b128 a[104:107], v10 offset:4096
    ds_read_b128 a[108:111], v11 offset:4096
    s_waitcnt lgkmcnt(0)
    v_mfma_f32_16x16x32_bf16 v[36:39], a[80:83], v[64:67], 0
    v_mfma_f32_16x16x32_bf16 v[36:39], a[84:87], v[68:71], v[36:39]
    v_mfma_f32_16x16x32_bf16 v[36:39], a[88:91], v[72:75], v[36:39]
    v_mfma_f32_16x16x32_bf16 v[36:39], a[92:95], v[76:79], v[36:39]
    v_mfma_f32_16x16x32_bf16 v[40:43], a[96:99], v[64:67], 0
    v_mfma_f32_16x16x32_bf16 v[40:43], a[100:103], v[68:71], v[40:43]
    v_mfma_f32_16x16x32_bf16 v[40:43], a[104:107], v[72:75], v[40:43]
    v_mfma_f32_16x16x32_bf16 v[40:43], a[108:111], v[76:79], v[40:43]
    s_nop 7
    s_nop 1
    v_max3_f32 v252, v252, v36, v37
    v_max3_f32 v252, v252, v38, v39
    v_max3_f32 v252, v252, v40, v41
    v_max3_f32 v252, v252, v42, v43
    s_nop 3
    v_mfma_f32_16x16x32_bf16 v[36:39], a[80:83], v[80:83], 0
    v_mfma_f32_16x16x32_bf16 v[36:39], a[84:87], v[84:87], v[36:39]
    v_mfma_f32_16x16x32_bf16 v[36:39], a[88:91], v[88:91], v[36:39]
    v_mfma_f32_16x16x32_bf16 v[36:39], a[92:95], v[92:95], v[36:39]
    v_mfma_f32_16x16x32_bf16 v[40:43], a[96:99], v[80:83], 0
    v_mfma_f32_16x16x32_bf16 v[40:43], a[100:103], v[84:87], v[40:43]
    v_mfma_f32_16x16x32_bf16 v[40:43], a[104:107], v[88:91], v[40:43]
    v_mfma_f32_16x16x32_bf16 v[40:43], a[108:111], v[92:95], v[40:43]
    s_nop 7
    s_nop 1
    v_max3_f32 v253, v253, v36, v37
    v_max3_f32 v253, v253, v38, v39
    v_max3_f32 v253, v253, v40, v41
    v_max3_f32 v253, v253, v42, v43
    s_nop 3
    v_mfma_f32_16x16x32_bf16 v[36:39], a[80:83], v[96:99], 0
    v_mfma_f32_16x16x32_bf16 v[36:39], a[84:87], v[100:103], v[36:39]
    v_mfma_f32_16x16x32_bf16 v[36:39], a[88:91], v[104:107], v[36:39]
    v_mfma_f32_16x16x32_bf16 v[36:39], a[92:95], v[108:111], v[36:39]
    v_mfma_f32_16x16x32_bf16 v[40:43], a[96:99], v[96:99], 0
    v_mfma_f32_16x16x32_bf16 v[40:43], a[100:103], v[100:103], v[40:43]
    v_mfma_f32_16x16x32_bf16 v[40:43], a[104:107], v[104:107], v[40:43]
    v_mfma_f32_16x16x32_bf16 v[40:43], a[108:111], v[108:111], v[40:43]
    s_nop 7
    s_nop 1
    v_max3_f32 v254, v254, v36, v37
    v_max3_f32 v254, v254, v38, v39
    v_max3_f32 v254, v254, v40, v41
    v_max3_f32 v254, v254, v42, v43
    s_nop 3
    v_mfma_f32_16x16x32_bf16 v[36:39], a[80:83], v[112:115], 0
    v_mfma_f32_16x16x32_bf16 v[36:39], a[84:87], v[116:119], v[36:39]
    v_mfma_f32_16x16x32_bf16 v[36:39], a[88:91], v[120:123], v[36:39]
    v_mfma_f32_16x16x32_bf16 v[36:39], a[92:95], v[124:127], v[36:39]
    v_mfma_f32_16x16x32_bf16 v[40:43], a[96:99], v[112:115], 0
    v_mfma_f32_16x16x32_bf16 v[40:43], a[100:103], v[116:119], v[40:43]
    v_mfma_f32_16x16x32_bf16 v[40:43], a[104:107], v[120:123], v[40:43]
    v_mfma_f32_16x16x32_bf16 v[40:43], a[108:111], v[124:127], v[40:43]
    s_nop 7
    s_nop 1
    v_max3_f32 v255, v255, v36, v37
    v_max3_f32 v255, v255, v38, v39
    v_max3_f32 v255, v255, v40, v41
    v_max3_f32 v255, v255, v42, v43
    s_nop 3
    v_mfma_f32_16x16x32_bf16 v[36:39], a[80:83], v[128:131], 0
    v_mfma_f32_16x16x32_bf16 v[36:39], a[84:87], v[132:135], v[36:39]
    v_mfma_f32_16x16x32_bf16 v[36:39], a[88:91], v[136:139], v[36:39]
    v_mfma_f32_16x16x32_bf16 v[36:39], a[92:95], v[140:143], v[36:39]
    v_mfma_f32_16x16x32_bf16 v[40:43], a[96:99], v[128:131], 0
    v_mfma_f32_16x16x32_bf16 v[40:43], a[100:103], v[132:135], v[40:43]
    v_mfma_f32_16x16x32_bf16 v[40:43], a[104:107], v[136:139], v[40:43]
    v_mfma_f32_16x16x32_bf16 v[40:43], a[108:111], v[140:143], v[40:43]
    s_nop 7
    s_nop 1
    v_max3_f32 v34, v34, v36, v37
    v_max3_f32 v34, v34, v38, v39
    v_max3_f32 v34, v34, v40, v41
    v_max3_f32 v34, v34, v42, v43
    s_nop 3
    s_add_u32 s24, s24, 16384
    s_cmp_lt_u32 s24, 262144
    s_cbranch_scc1 L_smax
    v_mov_b32 v1, v252
    s_nop 1
    v_permlane32_swap_b32 v1, v252
    s_nop 1
    v_max_f32 v252, v252, v1
    v_mov_b32 v1, v252
    s_nop 1
    v_permlane16_swap_b32 v1, v252
    s_nop 1
    v_max_f32 v252, v252, v1
    v_mov_b32 v1, v253
    s_nop 1
    v_permlane32_swap_b32 v1, v253
    s_nop 1
    v_max_f32 v253, v253, v1
    v_mov_b32 v1, v253
    s_nop 1
    v_permlane16_swap_b32 v1, v253
    s_nop 1
    v_max_f32 v253, v253, v1
    v_mov_b32 v1, v254
    s_nop 1
    v_permlane32_swap_b32 v1, v254
    s_nop 1
    v_max_f32 v254, v254, v1
    v_mov_b32 v1, v254
    s_nop 1
    v_permlane16_swap_b32 v1, v254
    s_nop 1
    v_max_f32 v254, v254, v1
    v_mov_b32 v1, v255
    s_nop 1
    v_permlane32_swap_b32 v1, v255
    s_nop 1
    v_max_f32 v255, v255, v1
    v_mov_b32 v1, v255
    s_nop 1
    v_permlane16_swap_b32 v1, v255
    s_nop 1
    v_max_f32 v255, v255, v1
    v_mov_b32 v1, v34
    s_nop 1
    v_permlane32_swap_b32 v1, v34
    s_nop 1
    v_max_f32 v34, v34, v1
    v_mov_b32 v1, v34
    s_nop 1
    v_permlane16_swap_b32 v1, v34
    s_nop 1
    v_max_f32 v34, v34, v1
    s_xor_b32 s49, s20, 1
    s_mul_i32 s48, s20, 1280
    s_mul_i32 s50, s49, 1280
    v_lshlrev_b32 v4, 2, v33
    v_add_u32 v4, 81920, v4
    v_add_u32 v5, s50, v4
    v_add_u32 v4, s48, v4
    s_barrier
    ds_write_b32 v4, v252 offset:0
    ds_write_b32 v4, v253 offset:256
    ds_write_b32 v4, v254 offset:512
    ds_write_b32 v4, v255 offset:768
    ds_write_b32 v4, v34 offset:1024
    s_waitcnt lgkmcnt(0)
    s_barrier
    ds_read_b32 v36, v5 offset:0
    ds_read_b32 v37, v5 offset:256
    ds_read_b32 v38, v5 offset:512
    ds_read_b32 v39, v5 offset:768
    ds_read_b32 v40, v5 offset:1024
    s_waitcnt lgkmcnt(0)
    v_max_f32 v252, v252, v36
    v_sub_f32 v232, 0, v252
    v_sub_f32 v233, 0, v252
    v_sub_f32 v234, 0, v252
    v_sub_f32 v235, 0, v252
    v_max_f32 v253, v253, v37
    v_sub_f32 v236, 0, v253
    v_sub_f32 v237, 0, v253
    v_sub_f32 v238, 0, v253
    v_sub_f32 v239, 0, v253
    v_max_f32 v254, v254, v38
    v_sub_f32 v240, 0, v254
    v_sub_f32 v241, 0, v254
    v_sub_f32 v242, 0, v254
    v_sub_f32 v243, 0, v254
    v_max_f32 v255, v255, v39
    v_sub_f32 v244, 0, v255
    v_sub_f32 v245, 0, v255
    v_sub_f32 v246, 0, v255
    v_sub_f32 v247, 0, v255
    v_max_f32 v34, v34, v40
    v_sub_f32 v248, 0, v34
    v_sub_f32 v249, 0, v34
    v_sub_f32 v250, 0, v34
    v_sub_f32 v251, 0, v34
    v_mov_b32 v144, 0
    v_mov_b32 v145, 0
    v_mov_b32 v146, 0
    v_mov_b32 v147, 0
    v_mov_b32 v148, 0
    v_mov_b32 v149, 0
    v_mov_b32 v150, 0
    v_mov_b32 v151, 0
    v_mov_b32 v152, 0
    v_mov_b32 v153, 0
    v_mov_b32 v154, 0
    v_mov_b32 v155, 0
    v_mov_b32 v156, 0
    v_mov_b32 v157, 0
    v_mov_b32 v158, 0
    v_mov_b32 v159, 0
    v_mov_b32 v160, 0
    v_mov_b32 v161, 0
    v_mov_b32 v162, 0
    v_mov_b32 v163, 0
    v_mov_b32 v164, 0
    v_mov_b32 v165, 0
    v_mov_b32 v166, 0
    v_mov_b32 v167, 0
    v_mov_b32 v168, 0
    v_mov_b32 v169, 0
    v_mov_b32 v170, 0
    v_mov_b32 v171, 0
    v_mov_b32 v172, 0
    v_mov_b32 v173, 0
    v_mov_b32 v174, 0
    v_mov_b32 v175, 0
    v_mov_b32 v176, 0
    v_mov_b32 v177, 0
    v_mov_b32 v178, 0
    v_mov_b32 v179, 0
    v_mov_b32 v180, 0
    v_mov_b32 v181, 0
    v_mov_b32 v182, 0
    v_mov_b32 v183, 0
    v_mov_b32 v184, 0
    v_mov_b32 v185, 0
    v_mov_b32 v186, 0
    v_mov_b32 v187, 0
    v_mov_b32 v188, 0
    v_mov_b32 v189, 0
    v_mov_b32 v190, 0
    v_mov_b32 v191, 0
    v_mov_b32 v192, 0
    v_mov_b32 v193, 0
    v_mov_b32 v194, 0
    v_mov_b32 v195, 0
    v_mov_b32 v196, 0
    v_mov_b32 v197, 0
    v_mov_b32 v198, 0
    v_mov_b32 v199, 0
    v_mov_b32 v200, 0
    v_mov_b32 v201, 0
    v_mov_b32 v202, 0
    v_mov_b32 v203, 0
    v_mov_b32 v204, 0
    v_mov_b32 v205, 0
    v_mov_b32 v206, 0
    v_mov_b32 v207, 0
    v_mov_b32 v208, 0
    v_mov_b32 v209, 0
    v_mov_b32 v210, 0
    v_mov_b32 v211, 0
    v_mov_b32 v212, 0
    v_mov_b32 v213, 0
    v_mov_b32 v214, 0
    v_mov_b32 v215, 0
    v_mov_b32 v216, 0
    v_mov_b32 v217, 0
    v_mov_b32 v218, 0
    v_mov_b32 v219, 0
    v_mov_b32 v220, 0
    v_mov_b32 v221, 0
    v_mov_b32 v222, 0
    v_mov_b32 v223, 0
    v_accvgpr_write_b32 a0, 0
    v_accvgpr_write_b32 a1, 0
    v_accvgpr_write_b32 a2, 0
    v_accvgpr_write_b32 a3, 0
    v_accvgpr_write_b32 a4, 0
    v_accvgpr_write_b32 a5, 0
    v_accvgpr_write_b32 a6, 0
    v_accvgpr_write_b32 a7, 0
    v_accvgpr_write_b32 a8, 0
    v_accvgpr_write_b32 a9, 0
    v_accvgpr_write_b32 a10, 0
    v_accvgpr_write_b32 a11, 0
    v_accvgpr_write_b32 a12, 0
    v_accvgpr_write_b32 a13, 0
    v_accvgpr_write_b32 a14, 0
    v_accvgpr_write_b32 a15, 0
    v_accvgpr_write_b32 a16, 0
    v_accvgpr_write_b32 a17, 0
    v_accvgpr_write_b32 a18, 0
    v_accvgpr_write_b32 a19, 0
    v_accvgpr_write_b32 a20, 0
    v_accvgpr_write_b32 a21, 0
    v_accvgpr_write_b32 a22, 0
    v_accvgpr_write_b32 a23, 0
    v_accvgpr_write_b32 a24, 0
    v_accvgpr_write_b32 a25, 0
    v_accvgpr_write_b32 a26, 0
    v_accvgpr_write_b32 a27, 0
    v_accvgpr_write_b32 a28, 0
    v_accvgpr_write_b32 a29, 0
    v_accvgpr_write_b32 a30, 0
    v_accvgpr_write_b32 a31, 0
    v_accvgpr_write_b32 a32, 0
    v_accvgpr_write_b32 a33, 0
    v_accvgpr_write_b32 a34, 0
    v_accvgpr_write_b32 a35, 0
    v_accvgpr_write_b32 a36, 0
    v_accvgpr_write_b32 a37, 0
    v_accvgpr_write_b32 a38, 0
    v_accvgpr_write_b32 a39, 0
    v_accvgpr_write_b32 a40, 0
    v_accvgpr_write_b32 a41, 0
    v_accvgpr_write_b32 a42, 0
    v_accvgpr_write_b32 a43, 0
    v_accvgpr_write_b32 a44, 0
    v_accvgpr_write_b32 a45, 0
    v_accvgpr_write_b32 a46, 0
    v_accvgpr_write_b32 a47, 0
    v_accvgpr_write_b32 a48, 0
    v_accvgpr_write_b32 a49, 0
    v_accvgpr_write_b32 a50, 0
    v_accvgpr_write_b32 a51, 0
    v_accvgpr_write_b32 a52, 0
    v_accvgpr_write_b32 a53, 0
    v_accvgpr_write_b32 a54, 0
    v_accvgpr_write_b32 a55, 0
    v_accvgpr_write_b32 a56, 0
    v_accvgpr_write_b32 a57, 0
    v_accvgpr_write_b32 a58, 0
    v_accvgpr_write_b32 a59, 0
    v_accvgpr_write_b32 a60, 0
    v_accvgpr_write_b32 a61, 0
    v_accvgpr_write_b32 a62, 0
    v_accvgpr_write_b32 a63, 0
    v_accvgpr_write_b32 a64, 0
    v_accvgpr_write_b32 a65, 0
    v_accvgpr_write_b32 a66, 0
    v_accvgpr_write_b32 a67, 0
    v_accvgpr_write_b32 a68, 0
    v_accvgpr_write_b32 a69, 0
    v_accvgpr_write_b32 a70, 0
    v_accvgpr_write_b32 a71, 0
    v_accvgpr_write_b32 a72, 0
    v_accvgpr_write_b32 a73, 0
    v_accvgpr_write_b32 a74, 0
    v_accvgpr_write_b32 a75, 0
    v_accvgpr_write_b32 a76, 0
    v_accvgpr_write_b32 a77, 0
    v_accvgpr_write_b32 a78, 0
    v_accvgpr_write_b32 a79, 0
    v_accvgpr_write_b32 a208, 0
    v_accvgpr_write_b32 a209, 0
    v_accvgpr_write_b32 a210, 0
    v_accvgpr_write_b32 a211, 0
    v_accvgpr_write_b32 a212, 0
    v_accvgpr_write_b32 a213, 0
    v_accvgpr_write_b32 a214, 0
    v_accvgpr_write_b32 a215, 0
    v_accvgpr_write_b32 a216, 0
    v_accvgpr_write_b32 a217, 0
    v_accvgpr_write_b32 a218, 0
    v_accvgpr_write_b32 a219, 0
    v_accvgpr_write_b32 a220, 0
    v_accvgpr_write_b32 a221, 0
    v_accvgpr_write_b32 a222, 0
    v_accvgpr_write_b32 a223, 0
    v_accvgpr_write_b32 a224, 0
    v_accvgpr_write_b32 a225, 0
    v_accvgpr_write_b32 a226, 0
    v_accvgpr_write_b32 a227, 0
    v_mov_b32 v28, 0
    v_mov_b32 v29, 0
    v_mov_b32 v30, 0
    v_mov_b32 v31, 0
    v_mov_b32 v32, 0
    s_mov_b32 s24, s23
L_smain:
    s_barrier
    s_add_u32 m0, s23, 0
    s_nop 0
    buffer_load_dwordx4 v20, s[8:11], s24 offen offset:0  lds
    buffer_load_dwordx4 v21, s[8:11], s24 offen offset:1024  lds
    buffer_load_dwordx4 v20, s[8:11], s24 offen offset:2048  lds
    buffer_load_dwordx4 v21, s[8:11], s24 offen offset:3072  lds
    s_add_u32 m0, s23, 65536
    s_nop 0
    buffer_load_dwordx4 v20, s[12:15], s24 offen offset:0  lds
    buffer_load_dwordx4 v21, s[12:15], s24 offen offset:1024  lds
    buffer_load_dwordx4 v20, s[12:15], s24 offen offset:2048  lds
    buffer_load_dwordx4 v21, s[12:15], s24 offen offset:3072  lds
    s_waitcnt vmcnt(0)
    s_barrier
    ds_read_b128 a[80:83], v8 offset:0
    ds_read_b128 a[84:87], v9 offset:0
    ds_read_b128 a[88:91], v10 offset:0
    ds_read_b128 a[92:95], v11 offset:0
    ds_read_b128 a[96:99], v8 offset:4096
    ds_read_b128 a[100:103], v9 offset:4096
    ds_read_b128 a[104:107], v10 offset:4096
    ds_read_b128 a[108:111], v11 offset:4096
    s_waitcnt lgkmcnt(0)
    ds_read_b64_tr_b16 a[144:145], v12 offset:0
    ds_read_b64_tr_b16 a[146:147], v12 offset:4096
    ds_read_b64_tr_b16 a[148:149], v13 offset:0
    ds_read_b64_tr_b16 a[150:151], v13 offset:4096
    ds_read_b64_tr_b16 a[152:153], v14 offset:0
    ds_read_b64_tr_b16 a[154:155], v14 offset:4096
    ds_read_b64_tr_b16 a[156:157], v15 offset:0
    ds_read_b64_tr_b16 a[158:159], v15 offset:4096
    ds_read_b64_tr_b16 a[160:161], v16 offset:0
    ds_read_b64_tr_b16 a[162:163], v16 offset:4096
    ds_read_b64_tr_b16 a[164:165], v17 offset:0
    ds_read_b64_tr_b16 a[166:167], v17 offset:4096
    ds_read_b64_tr_b16 a[168:169], v18 offset:0
    ds_read_b64_tr_b16 a[170:171], v18 offset:4096
    ds_read_b64_tr_b16 a[172:173], v19 offset:0
    ds_read_b64_tr_b16 a[174:175], v19 offset:4096
    s_waitcnt lgkmcnt(0)
    v_mfma_f32_16x16x32_bf16 v[36:39], a[80:83], v[64:67], v[232:235]
    v_mfma_f32_16x16x32_bf16 v[36:39], a[84:87], v[68:71], v[36:39]
    v_mfma_f32_16x16x32_bf16 v[36:39], a[88:91], v[72:75], v[36:39]
    v_mfma_f32_16x16x32_bf16 v[36:39], a[92:95], v[76:79], v[36:39]
    v_mfma_f32_16x16x32_bf16 v[40:43], a[96:99], v[64:67], v[232:235]
    v_mfma_f32_16x16x32_bf16 v[40:43], a[100:103], v[68:71], v[40:43]
    v_mfma_f32_16x16x32_bf16 v[40:43], a[104:107], v[72:75], v[40:43]
    v_mfma_f32_16x16x32_bf16 v[40:43], a[108:111], v[76:79], v[40:43]
    s_nop 7
    s_nop 1
    v_exp_f32 v36, v36
    v_exp_f32 v37, v37
    v_exp_f32 v38, v38
    v_exp_f32 v39, v39
    v_exp_f32 v40, v40
    v_exp_f32 v41, v41
    v_exp_f32 v42, v42
    v_exp_f32 v43, v43
    s_nop 0
    v_add_f32 v28, v28, v36
    v_add_f32 v28, v28, v37
    v_add_f32 v28, v28, v38
    v_add_f32 v28, v28, v39
    v_add_f32 v28, v28, v40
    v_add_f32 v28, v28, v41
    v_add_f32 v28, v28, v42
    v_add_f32 v28, v28, v43
    v_cvt_pk_bf16_f32 v52, v36, v37
    v_cvt_pk_bf16_f32 v53, v38, v39
    v_cvt_pk_bf16_f32 v54, v40, v41
    v_cvt_pk_bf16_f32 v55, v42, v43
    s_nop 1
    v_mfma_f32_16x16x32_bf16 v[144:147], a[144:147], v[52:55], v[144:147]
    v_mfma_f32_16x16x32_bf16 v[148:151], a[148:151], v[52:55], v[148:151]
    v_mfma_f32_16x16x32_bf16 v[152:155], a[152:155], v[52:55], v[152:155]
    v_mfma_f32_16x16x32_bf16 v[156:159], a[156:159], v[52:55], v[156:159]
    v_mfma_f32_16x16x32_bf16 a[0:3], a[160:163], v[52:55], a[0:3]
    v_mfma_f32_16x16x32_bf16 a[4:7], a[164:167], v[52:55], a[4:7]
    v_mfma_f32_16x16x32_bf16 a[8:11], a[168:171], v[52:55], a[8:11]
    v_mfma_f32_16x16x32_bf16 a[12:15], a[172:175], v[52:55], a[12:15]
    s_nop 3
    v_mfma_f32_16x16x32_bf16 v[36:39], a[80:83], v[80:83], v[236:239]
    v_mfma_f32_16x16x32_bf16 v[36:39], a[84:87], v[84:87], v[36:39]
    v_mfma_f32_16x16x32_bf16 v[36:39], a[88:91], v[88:91], v[36:39]
    v_mfma_f32_16x16x32_bf16 v[36:39], a[92:95], v[92:95], v[36:39]
    v_mfma_f32_16x16x32_bf16 v[40:43], a[96:99], v[80:83], v[236:239]
    v_mfma_f32_16x16x32_bf16 v[40:43], a[100:103], v[84:87], v[40:43]
    v_mfma_f32_16x16x32_bf16 v[40:43], a[104:107], v[88:91], v[40:43]
    v_mfma_f32_16x16x32_bf16 v[40:43], a[108:111], v[92:95], v[40:43]
    s_nop 7
    s_nop 1
    v_exp_f32 v36, v36
    v_exp_f32 v37, v37
    v_exp_f32 v38, v38
    v_exp_f32 v39, v39
    v_exp_f32 v40, v40
    v_exp_f32 v41, v41
    v_exp_f32 v42, v42
    v_exp_f32 v43, v43
    s_nop 0
    v_add_f32 v29, v29, v36
    v_add_f32 v29, v29, v37
    v_add_f32 v29, v29, v38
    v_add_f32 v29, v29, v39
    v_add_f32 v29, v29, v40
    v_add_f32 v29, v29, v41
    v_add_f32 v29, v29, v42
    v_add_f32 v29, v29, v43
    v_cvt_pk_bf16_f32 v52, v36, v37
    v_cvt_pk_bf16_f32 v53, v38, v39
    v_cvt_pk_bf16_f32 v54, v40, v41
    v_cvt_pk_bf16_f32 v55, v42, v43
    s_nop 1
    v_mfma_f32_16x16x32_bf16 v[160:163], a[144:147], v[52:55], v[160:163]
    v_mfma_f32_16x16x32_bf16 v[164:167], a[148:151], v[52:55], v[164:167]
    v_mfma_f32_16x16x32_bf16 v[168:171], a[152:155], v[52:55], v[168:171]
    v_mfma_f32_16x16x32_bf16 v[172:175], a[156:159], v[52:55], v[172:175]
    v_mfma_f32_16x16x32_bf16 a[16:19], a[160:163], v[52:55], a[16:19]
    v_mfma_f32_16x16x32_bf16 a[20:23], a[164:167], v[52:55], a[20:23]
    v_mfma_f32_16x16x32_bf16 a[24:27], a[168:171], v[52:55], a[24:27]
    v_mfma_f32_16x16x32_bf16 a[28:31], a[172:175], v[52:55], a[28:31]
    s_nop 3
    v_mfma_f32_16x16x32_bf16 v[36:39], a[80:83], v[96:99], v[240:243]
    v_mfma_f32_16x16x32_bf16 v[36:39], a[84:87], v[100:103], v[36:39]
    v_mfma_f32_16x16x32_bf16 v[36:39], a[88:91], v[104:107], v[36:39]
    v_mfma_f32_16x16x32_bf16 v[36:39], a[92:95], v[108:111], v[36:39]
    v_mfma_f32_16x16x32_bf16 v[40:43], a[96:99], v[96:99], v[240:243]
    v_mfma_f32_16x16x32_bf16 v[40:43], a[100:103], v[100:103], v[40:43]
    v_mfma_f32_16x16x32_bf16 v[40:43], a[104:107], v[104:107], v[40:43]
    v_mfma_f32_16x16x32_bf16 v[40:43], a[108:111], v[108:111], v[40:43]
    s_nop 7
    s_nop 1
    v_exp_f32 v36, v36
    v_exp_f32 v37, v37
    v_exp_f32 v38, v38
    v_exp_f32 v39, v39
    v_exp_f32 v40, v40
    v_exp_f32 v41, v41
    v_exp_f32 v42, v42
    v_exp_f32 v43, v43
    s_nop 0
    v_cvt_pk_bf16_f32 v52, v36, v37
    v_cvt_pk_bf16_f32 v53, v38, v39
    v_cvt_pk_bf16_f32 v54, v40, v41
    v_cvt_pk_bf16_f32 v55, v42, v43
    s_nop 1
    v_mfma_f32_16x16x32_bf16 v[176:179], a[144:147], v[52:55], v[176:179]
    v_mfma_f32_16x16x32_bf16 v[180:183], a[148:151], v[52:55], v[180:183]
    v_mfma_f32_16x16x32_bf16 v[184:187], a[152:155], v[52:55], v[184:187]
    v_mfma_f32_16x16x32_bf16 v[188:191], a[156:159], v[52:55], v[188:191]
    v_mfma_f32_16x16x32_bf16 a[32:35], a[160:163], v[52:55], a[32:35]
    v_mfma_f32_16x16x32_bf16 a[36:39], a[164:167], v[52:55], a[36:39]
    v_mfma_f32_16x16x32_bf16 a[40:43], a[168:171], v[52:55], a[40:43]
    v_mfma_f32_16x16x32_bf16 a[44:47], a[172:175], v[52:55], a[44:47]
    v_mfma_f32_16x16x32_bf16 a[216:219], v[24:27], v[52:55], a[216:219]
    s_nop 3
    v_mfma_f32_16x16x32_bf16 v[36:39], a[80:83], v[112:115], v[244:247]
    v_mfma_f32_16x16x32_bf16 v[36:39], a[84:87], v[116:119], v[36:39]
    v_mfma_f32_16x16x32_bf16 v[36:39], a[88:91], v[120:123], v[36:39]
    v_mfma_f32_16x16x32_bf16 v[36:39], a[92:95], v[124:127], v[36:39]
    v_mfma_f32_16x16x32_bf16 v[40:43], a[96:99], v[112:115], v[244:247]
    v_mfma_f32_16x16x32_bf16 v[40:43], a[100:103], v[116:119], v[40:43]
    v_mfma_f32_16x16x32_bf16 v[40:43], a[104:107], v[120:123], v[40:43]
    v_mfma_f32_16x16x32_bf16 v[40:43], a[108:111], v[124:127], v[40:43]
    s_nop 7
    s_nop 1
    v_exp_f32 v36, v36
    v_exp_f32 v37, v37
    v_exp_f32 v38, v38
    v_exp_f32 v39, v39
    v_exp_f32 v40, v40
    v_exp_f32 v41, v41
    v_exp_f32 v42, v42
    v_exp_f32 v43, v43
    s_nop 0
    v_cvt_pk_bf16_f32 v52, v36, v37
    v_cvt_pk_bf16_f32 v53, v38, v39
    v_cvt_pk_bf16_f32 v54, v40, v41
    v_cvt_pk_bf16_f32 v55, v42, v43
    s_nop 1
    v_mfma_f32_16x16x32_bf16 v[192:195], a[144:147], v[52:55], v[192:195]
    v_mfma_f32_16x16x32_bf16 v[196:199], a[148:151], v[52:55], v[196:199]
    v_mfma_f32_16x16x32_bf16 v[200:203], a[152:155], v[52:55], v[200:203]
    v_mfma_f32_16x16x32_bf16 v[204:207], a[156:159], v[52:55], v[204:207]
    v_mfma_f32_16x16x32_bf16 a[48:51], a[160:163], v[52:55], a[48:51]
    v_mfma_f32_16x16x32_bf16 a[52:55], a[164:167], v[52:55], a[52:55]
    v_mfma_f32_16x16x32_bf16 a[56:59], a[168:171], v[52:55], a[56:59]
    v_mfma_f32_16x16x32_bf16 a[60:63], a[172:175], v[52:55], a[60:63]
    v_mfma_f32_16x16x32_bf16 a[220:223], v[24:27], v[52:55], a[220:223]
    s_nop 3
    v_mfma_f32_16x16x32_bf16 v[36:39], a[80:83], v[128:131], v[248:251]
    v_mfma_f32_16x16x32_bf16 v[36:39], a[84:87], v[132:135], v[36:39]
    v_mfma_f32_16x16x32_bf16 v[36:39], a[88:91], v[136:139], v[36:39]
    v_mfma_f32_16x16x32_bf16 v[36:39], a[92:95], v[140:143], v[36:39]
    v_mfma_f32_16x16x32_bf16 v[40:43], a[96:99], v[128:131], v[248:251]
    v_mfma_f32_16x16x32_bf16 v[40:43], a[100:103], v[132:135], v[40:43]
    v_mfma_f32_16x16x32_bf16 v[40:43], a[104:107], v[136:139], v[40:43]
    v_mfma_f32_16x16x32_bf16 v[40:43], a[108:111], v[140:143], v[40:43]
    s_nop 7
    s_nop 1
    v_exp_f32 v36, v36
    v_exp_f32 v37, v37
    v_exp_f32 v38, v38
    v_exp_f32 v39, v39
    v_exp_f32 v40, v40
    v_exp_f32 v41, v41
    v_exp_f32 v42, v42
    v_exp_f32 v43, v43
    s_nop 0
    v_add_f32 v32, v32, v36
    v_add_f32 v32, v32, v37
    v_add_f32 v32, v32, v38
    v_add_f32 v32, v32, v39
    v_add_f32 v32, v32, v40
    v_add_f32 v32, v32, v41
    v_add_f32 v32, v32, v42
    v_add_f32 v32, v32, v43
    v_cvt_pk_bf16_f32 v52, v36, v37
    v_cvt_pk_bf16_f32 v53, v38, v39
    v_cvt_pk_bf16_f32 v54, v40, v41
    v_cvt_pk_bf16_f32 v55, v42, v43
    s_nop 1
    v_mfma_f32_16x16x32_bf16 v[208:211], a[144:147], v[52:55], v[208:211]
    v_mfma_f32_16x16x32_bf16 v[212:215], a[148:151], v[52:55], v[212:215]
    v_mfma_f32_16x16x32_bf16 v[216:219], a[152:155], v[52:55], v[216:219]
    v_mfma_f32_16x16x32_bf16 v[220:223], a[156:159], v[52:55], v[220:223]
    v_mfma_f32_16x16x32_bf16 a[64:67], a[160:163], v[52:55], a[64:67]
    v_mfma_f32_16x16x32_bf16 a[68:71], a[164:167], v[52:55], a[68:71]
    v_mfma_f32_16x16x32_bf16 a[72:75], a[168:171], v[52:55], a[72:75]
    v_mfma_f32_16x16x32_bf16 a[76:79], a[172:175], v[52:55], a[76:79]
    s_nop 3
    s_add_u32 s24, s24, 16384
    s_cmp_lt_u32 s24, 262144
    s_cbranch_scc1 L_smain
    s_barrier
    s_nop 7
    s_nop 7
    s_mul_i32 s48, s20, 20480
    s_xor_b32 s49, s20, 1
    s_mul_i32 s50, s49, 20480
    v_lshlrev_b32 v2, 4, v33
    v_add_u32 v35, s50, v2
    v_add_u32 v34, s48, v2
    s_mul_i32 s48, s21, 2560
    s_add_u32 s48, s48, 81920
    s_lshl_b32 s50, s22, 4
    v_and_b32 v4, 15, v33
    v_lshlrev_b32 v5, 5, v4
    v_add_u32 v5, s48, v5
    v_lshrrev_b32 v6, 3, v4
    v_lshl_add_u32 v61, v6, 4, v5
    v_xor_b32 v6, 1, v6
    v_lshl_add_u32 v22, v6, 4, v5
    s_lshl_b32 s50, s22, 2
    v_lshrrev_b32 v6, 2, v4
    v_lshlrev_b32 v6, 1, v6
    v_lshrrev_b32 v7, 4, v33
    v_add_u32 v6, v6, v7
    v_add_u32 v6, s50, v6
    v_and_b32 v6, 7, v6
    v_lshl_add_u32 v60, v6, 2, v5
    v_and_b32 v6, 15, v33
    v_lshrrev_b32 v7, 4, v33
    s_mul_i32 s48, s20, 10240
    s_add_u32 s48, s48, 98304
    v_lshlrev_b32 v1, 7, v6
    v_add_u32 v1, s48, v1
    v_lshrrev_b32 v2, 3, v6
    v_xor_b32 v2, v2, v7
    v_and_b32 v2, 1, v2
    v_lshl_add_u32 v1, v2, 3, v1
    v_lshrrev_b32 v2, 1, v7
    v_and_b32 v3, 7, v6
    v_xor_b32 v2, v2, v3
    v_xor_b32 v3, 0, v2
    v_lshl_add_u32 v244, v3, 4, v1
    v_xor_b32 v3, 2, v2
    v_lshl_add_u32 v245, v3, 4, v1
    v_xor_b32 v3, 4, v2
    v_lshl_add_u32 v246, v3, 4, v1
    v_xor_b32 v3, 6, v2
    v_lshl_add_u32 v247, v3, 4, v1
    v_lshrrev_b32 v6, 3, v33
    v_and_b32 v7, 7, v33
    v_xor_b32 v1, v6, v7
    v_lshlrev_b32 v1, 4, v1
    v_lshl_add_u32 v1, v6, 7, v1
    v_add_u32 v248, s48, v1
    s_mul_i32 s49, s21, 20480
    s_lshl_b32 s50, s22, 7
    s_add_u32 s49, s49, s50
    v_lshlrev_b32 v7, 4, v7
    v_lshl_add_u32 v7, v6, 8, v7
    v_add_u32 v249, s49, v7
    ds_write_b32 v60, v28 offset:0
    ds_write_b128 v34, a[0:3] offset:0
    ds_write_b128 v34, a[4:7] offset:1024
    ds_write_b128 v34, a[8:11] offset:2048
    ds_write_b128 v34, a[12:15] offset:3072
    ds_write_b32 v60, v29 offset:512
    ds_write_b128 v34, a[16:19] offset:4096
    ds_write_b128 v34, a[20:23] offset:5120
    ds_write_b128 v34, a[24:27] offset:6144
    ds_write_b128 v34, a[28:31] offset:7168
    v_accvgpr_read_b32 v30, a216
    ds_write_b32 v60, v30 offset:1024
    ds_write_b128 v34, a[32:35] offset:8192
    ds_write_b128 v34, a[36:39] offset:9216
    ds_write_b128 v34, a[40:43] offset:10240
    ds_write_b128 v34, a[44:47] offset:11264
    v_accvgpr_read_b32 v31, a220
    ds_write_b32 v60, v31 offset:1536
    ds_write_b128 v34, a[48:51] offset:12288
    ds_write_b128 v34, a[52:55] offset:13312
    ds_write_b128 v34, a[56:59] offset:14336
    ds_write_b128 v34, a[60:63] offset:15360
    ds_write_b32 v60, v32 offset:2048
    ds_write_b128 v34, a[64:67] offset:16384
    ds_write_b128 v34, a[68:71] offset:17408
    ds_write_b128 v34, a[72:75] offset:18432
    ds_write_b128 v34, a[76:79] offset:19456
    s_waitcnt lgkmcnt(0)
    s_barrier
    ds_read_b128 v[234:237], v61 offset:0
    ds_read_b128 v[238:241], v22 offset:0
    ds_read_b128 v[64:67], v35 offset:0
    ds_read_b128 v[68:71], v35 offset:1024
    ds_read_b128 v[72:75], v35 offset:2048
    ds_read_b128 v[76:79], v35 offset:3072
    s_waitcnt lgkmcnt(0)
    v_pk_add_f32 v[234:235], v[234:235], v[236:237]
    v_pk_add_f32 v[238:239], v[238:239], v[240:241]
    v_pk_add_f32 v[144:145], v[144:145], v[64:65]
    v_pk_add_f32 v[234:235], v[234:235], v[238:239]
    v_pk_add_f32 v[146:147], v[146:147], v[66:67]
    v_add_f32 v28, v234, v235
    v_pk_add_f32 v[148:149], v[148:149], v[68:69]
    v_rcp_f32 v224, v28
    v_pk_add_f32 v[150:151], v[150:151], v[70:71]
    v_pk_add_f32 v[152:153], v[152:153], v[72:73]
    v_pk_add_f32 v[154:155], v[154:155], v[74:75]
    v_pk_add_f32 v[156:157], v[156:157], v[76:77]
    v_pk_add_f32 v[158:159], v[158:159], v[78:79]
    v_pk_mul_f32 v[144:145], v[144:145], v[224:225] op_sel_hi:[1,0]
    v_pk_mul_f32 v[146:147], v[146:147], v[224:225] op_sel_hi:[1,0]
    v_cvt_pk_bf16_f32 v144, v144, v145
    v_cvt_pk_bf16_f32 v145, v146, v147
    v_pk_mul_f32 v[148:149], v[148:149], v[224:225] op_sel_hi:[1,0]
    v_pk_mul_f32 v[150:151], v[150:151], v[224:225] op_sel_hi:[1,0]
    ds_write_b64 v244, v[144:145] offset:0
    v_cvt_pk_bf16_f32 v148, v148, v149
    v_cvt_pk_bf16_f32 v149, v150, v151
    v_pk_mul_f32 v[152:153], v[152:153], v[224:225] op_sel_hi:[1,0]
    v_pk_mul_f32 v[154:155], v[154:155], v[224:225] op_sel_hi:[1,0]
    ds_write_b64 v245, v[148:149] offset:0
    v_cvt_pk_bf16_f32 v152, v152, v153
    v_cvt_pk_bf16_f32 v153, v154, v155
    v_pk_mul_f32 v[156:157], v[156:157], v[224:225] op_sel_hi:[1,0]
    v_pk_mul_f32 v[158:159], v[158:159], v[224:225] op_sel_hi:[1,0]
    ds_write_b64 v246, v[152:153] offset:0
    v_cvt_pk_bf16_f32 v156, v156, v157
    v_cvt_pk_bf16_f32 v157, v158, v159
    ds_write_b64 v247, v[156:157] offset:0
    ds_read_b128 v[36:39], v248 offset:0
    ds_read_b64 v[40:41], v248 offset:1032
    ds_read_b64 v[42:43], v248 offset:1024
    s_mov_b32 s54, 0
    s_mov_b32 s55, 2048
    s_waitcnt lgkmcnt(0)
    buffer_store_dwordx4 v[36:39], v249, s[16:19], s54 offen sc1 nt
    buffer_store_dwordx4 v[40:43], v249, s[16:19], s55 offen sc1 nt
    ds_read_b128 v[0:3], v61 offset:512
    ds_read_b128 v[4:7], v22 offset:512
    ds_read_b128 v[80:83], v35 offset:4096
    ds_read_b128 v[84:87], v35 offset:5120
    ds_read_b128 v[88:91], v35 offset:6144
    ds_read_b128 v[92:95], v35 offset:7168
    s_waitcnt lgkmcnt(0)
    v_pk_add_f32 v[0:1], v[0:1], v[2:3]
    v_pk_add_f32 v[4:5], v[4:5], v[6:7]
    v_pk_add_f32 v[160:161], v[160:161], v[80:81]
    v_pk_add_f32 v[0:1], v[0:1], v[4:5]
    v_pk_add_f32 v[162:163], v[162:163], v[82:83]
    v_add_f32 v29, v0, v1
    v_pk_add_f32 v[164:165], v[164:165], v[84:85]
    v_rcp_f32 v226, v29
    v_pk_add_f32 v[166:167], v[166:167], v[86:87]
    v_pk_add_f32 v[168:169], v[168:169], v[88:89]
    v_pk_add_f32 v[170:171], v[170:171], v[90:91]
    v_pk_add_f32 v[172:173], v[172:173], v[92:93]
    v_pk_add_f32 v[174:175], v[174:175], v[94:95]
    v_pk_mul_f32 v[160:161], v[160:161], v[226:227] op_sel_hi:[1,0]
    v_pk_mul_f32 v[162:163], v[162:163], v[226:227] op_sel_hi:[1,0]
    v_cvt_pk_bf16_f32 v160, v160, v161
    v_cvt_pk_bf16_f32 v161, v162, v163
    v_pk_mul_f32 v[164:165], v[164:165], v[226:227] op_sel_hi:[1,0]
    v_pk_mul_f32 v[166:167], v[166:167], v[226:227] op_sel_hi:[1,0]
    ds_write_b64 v244, v[160:161] offset:2048
    v_cvt_pk_bf16_f32 v164, v164, v165
    v_cvt_pk_bf16_f32 v165, v166, v167
    v_pk_mul_f32 v[168:169], v[168:169], v[226:227] op_sel_hi:[1,0]
    v_pk_mul_f32 v[170:171], v[170:171], v[226:227] op_sel_hi:[1,0]
    ds_write_b64 v245, v[164:165] offset:2048
    v_cvt_pk_bf16_f32 v168, v168, v169
    v_cvt_pk_bf16_f32 v169, v170, v171
    v_pk_mul_f32 v[172:173], v[172:173], v[226:227] op_sel_hi:[1,0]
    v_pk_mul_f32 v[174:175], v[174:175], v[226:227] op_sel_hi:[1,0]
    ds_write_b64 v246, v[168:169] offset:2048
    v_cvt_pk_bf16_f32 v172, v172, v173
    v_cvt_pk_bf16_f32 v173, v174, v175
    ds_write_b64 v247, v[172:173] offset:2048
    ds_read_b128 v[44:47], v248 offset:2048
    ds_read_b64 v[48:49], v248 offset:3080
    ds_read_b64 v[50:51], v248 offset:3072
    s_mov_b32 s54, 4096
    s_mov_b32 s55, 6144
    s_waitcnt lgkmcnt(0)
    buffer_store_dwordx4 v[44:47], v249, s[16:19], s54 offen sc1 nt
    buffer_store_dwordx4 v[48:51], v249, s[16:19], s55 offen sc1 nt
    ds_read_b128 v[234:237], v61 offset:1024
    ds_read_b128 v[238:241], v22 offset:1024
    ds_read_b128 v[96:99], v35 offset:8192
    ds_read_b128 v[100:103], v35 offset:9216
    ds_read_b128 v[104:107], v35 offset:10240
    ds_read_b128 v[108:111], v35 offset:11264
    s_waitcnt lgkmcnt(0)
    v_pk_add_f32 v[234:235], v[234:235], v[236:237]
    v_pk_add_f32 v[238:239], v[238:239], v[240:241]
    v_pk_add_f32 v[176:177], v[176:177], v[96:97]
    v_pk_add_f32 v[234:235], v[234:235], v[238:239]
    v_pk_add_f32 v[178:179], v[178:179], v[98:99]
    v_add_f32 v30, v234, v235
    v_pk_add_f32 v[180:181], v[180:181], v[100:101]
    v_rcp_f32 v228, v30
    v_pk_add_f32 v[182:183], v[182:183], v[102:103]
    v_pk_add_f32 v[184:185], v[184:185], v[104:105]
    v_pk_add_f32 v[186:187], v[186:187], v[106:107]
    v_pk_add_f32 v[188:189], v[188:189], v[108:109]
    v_pk_add_f32 v[190:191], v[190:191], v[110:111]
    v_pk_mul_f32 v[176:177], v[176:177], v[228:229] op_sel_hi:[1,0]
    v_pk_mul_f32 v[178:179], v[178:179], v[228:229] op_sel_hi:[1,0]
    v_cvt_pk_bf16_f32 v176, v176, v177
    v_cvt_pk_bf16_f32 v177, v178, v179
    v_pk_mul_f32 v[180:181], v[180:181], v[228:229] op_sel_hi:[1,0]
    v_pk_mul_f32 v[182:183], v[182:183], v[228:229] op_sel_hi:[1,0]
    ds_write_b64 v244, v[176:177] offset:4096
    v_cvt_pk_bf16_f32 v180, v180, v181
    v_cvt_pk_bf16_f32 v181, v182, v183
    v_pk_mul_f32 v[184:185], v[184:185], v[228:229] op_sel_hi:[1,0]
    v_pk_mul_f32 v[186:187], v[186:187], v[228:229] op_sel_hi:[1,0]
    ds_write_b64 v245, v[180:181] offset:4096
    v_cvt_pk_bf16_f32 v184, v184, v185
    v_cvt_pk_bf16_f32 v185, v186, v187
    v_pk_mul_f32 v[188:189], v[188:189], v[228:229] op_sel_hi:[1,0]
    v_pk_mul_f32 v[190:191], v[190:191], v[228:229] op_sel_hi:[1,0]
    ds_write_b64 v246, v[184:185] offset:4096
    v_cvt_pk_bf16_f32 v188, v188, v189
    v_cvt_pk_bf16_f32 v189, v190, v191
    ds_write_b64 v247, v[188:189] offset:4096
    ds_read_b128 v[36:39], v248 offset:4096
    ds_read_b64 v[40:41], v248 offset:5128
    ds_read_b64 v[42:43], v248 offset:5120
    s_mov_b32 s54, 8192
    s_mov_b32 s55, 10240
    s_waitcnt lgkmcnt(0)
    buffer_store_dwordx4 v[36:39], v249, s[16:19], s54 offen sc1 nt
    buffer_store_dwordx4 v[40:43], v249, s[16:19], s55 offen sc1 nt
    ds_read_b128 v[0:3], v61 offset:1536
    ds_read_b128 v[4:7], v22 offset:1536
    ds_read_b128 v[112:115], v35 offset:12288
    ds_read_b128 v[116:119], v35 offset:13312
    ds_read_b128 v[120:123], v35 offset:14336
    ds_read_b128 v[124:127], v35 offset:15360
    s_waitcnt lgkmcnt(0)
    v_pk_add_f32 v[0:1], v[0:1], v[2:3]
    v_pk_add_f32 v[4:5], v[4:5], v[6:7]
    v_pk_add_f32 v[192:193], v[192:193], v[112:113]
    v_pk_add_f32 v[0:1], v[0:1], v[4:5]
    v_pk_add_f32 v[194:195], v[194:195], v[114:115]
    v_add_f32 v31, v0, v1
    v_pk_add_f32 v[196:197], v[196:197], v[116:117]
    v_rcp_f32 v230, v31
    v_pk_add_f32 v[198:199], v[198:199], v[118:119]
    v_pk_add_f32 v[200:201], v[200:201], v[120:121]
    v_pk_add_f32 v[202:203], v[202:203], v[122:123]
    v_pk_add_f32 v[204:205], v[204:205], v[124:125]
    v_pk_add_f32 v[206:207], v[206:207], v[126:127]
    v_pk_mul_f32 v[192:193], v[192:193], v[230:231] op_sel_hi:[1,0]
    v_pk_mul_f32 v[194:195], v[194:195], v[230:231] op_sel_hi:[1,0]
    v_cvt_pk_bf16_f32 v192, v192, v193
    v_cvt_pk_bf16_f32 v193, v194, v195
    v_pk_mul_f32 v[196:197], v[196:197], v[230:231] op_sel_hi:[1,0]
    v_pk_mul_f32 v[198:199], v[198:199], v[230:231] op_sel_hi:[1,0]
    ds_write_b64 v244, v[192:193] offset:6144
    v_cvt_pk_bf16_f32 v196, v196, v197
    v_cvt_pk_bf16_f32 v197, v198, v199
    v_pk_mul_f32 v[200:201], v[200:201], v[230:231] op_sel_hi:[1,0]
    v_pk_mul_f32 v[202:203], v[202:203], v[230:231] op_sel_hi:[1,0]
    ds_write_b64 v245, v[196:197] offset:6144
    v_cvt_pk_bf16_f32 v200, v200, v201
    v_cvt_pk_bf16_f32 v201, v202, v203
    v_pk_mul_f32 v[204:205], v[204:205], v[230:231] op_sel_hi:[1,0]
    v_pk_mul_f32 v[206:207], v[206:207], v[230:231] op_sel_hi:[1,0]
    ds_write_b64 v246, v[200:201] offset:6144
    v_cvt_pk_bf16_f32 v204, v204, v205
    v_cvt_pk_bf16_f32 v205, v206, v207
    ds_write_b64 v247, v[204:205] offset:6144
    ds_read_b128 v[44:47], v248 offset:6144
    ds_read_b64 v[48:49], v248 offset:7176
    ds_read_b64 v[50:51], v248 offset:7168
    s_mov_b32 s54, 12288
    s_mov_b32 s55, 14336
    s_waitcnt lgkmcnt(0)
    buffer_store_dwordx4 v[44:47], v249, s[16:19], s54 offen sc1 nt
    buffer_store_dwordx4 v[48:51], v249, s[16:19], s55 offen sc1 nt
    ds_read_b128 v[234:237], v61 offset:2048
    ds_read_b128 v[238:241], v22 offset:2048
    ds_read_b128 v[128:131], v35 offset:16384
    ds_read_b128 v[132:135], v35 offset:17408
    ds_read_b128 v[136:139], v35 offset:18432
    ds_read_b128 v[140:143], v35 offset:19456
    s_waitcnt lgkmcnt(0)
    v_pk_add_f32 v[234:235], v[234:235], v[236:237]
    v_pk_add_f32 v[238:239], v[238:239], v[240:241]
    v_pk_add_f32 v[208:209], v[208:209], v[128:129]
    v_pk_add_f32 v[234:235], v[234:235], v[238:239]
    v_pk_add_f32 v[210:211], v[210:211], v[130:131]
    v_add_f32 v32, v234, v235
    v_pk_add_f32 v[212:213], v[212:213], v[132:133]
    v_rcp_f32 v232, v32
    v_pk_add_f32 v[214:215], v[214:215], v[134:135]
    v_pk_add_f32 v[216:217], v[216:217], v[136:137]
    v_pk_add_f32 v[218:219], v[218:219], v[138:139]
    v_pk_add_f32 v[220:221], v[220:221], v[140:141]
    v_pk_add_f32 v[222:223], v[222:223], v[142:143]
    v_pk_mul_f32 v[208:209], v[208:209], v[232:233] op_sel_hi:[1,0]
    v_pk_mul_f32 v[210:211], v[210:211], v[232:233] op_sel_hi:[1,0]
    v_cvt_pk_bf16_f32 v208, v208, v209
    v_cvt_pk_bf16_f32 v209, v210, v211
    v_pk_mul_f32 v[212:213], v[212:213], v[232:233] op_sel_hi:[1,0]
    v_pk_mul_f32 v[214:215], v[214:215], v[232:233] op_sel_hi:[1,0]
    ds_write_b64 v244, v[208:209] offset:8192
    v_cvt_pk_bf16_f32 v212, v212, v213
    v_cvt_pk_bf16_f32 v213, v214, v215
    v_pk_mul_f32 v[216:217], v[216:217], v[232:233] op_sel_hi:[1,0]
    v_pk_mul_f32 v[218:219], v[218:219], v[232:233] op_sel_hi:[1,0]
    ds_write_b64 v245, v[212:213] offset:8192
    v_cvt_pk_bf16_f32 v216, v216, v217
    v_cvt_pk_bf16_f32 v217, v218, v219
    v_pk_mul_f32 v[220:221], v[220:221], v[232:233] op_sel_hi:[1,0]
    v_pk_mul_f32 v[222:223], v[222:223], v[232:233] op_sel_hi:[1,0]
    ds_write_b64 v246, v[216:217] offset:8192
    v_cvt_pk_bf16_f32 v220, v220, v221
    v_cvt_pk_bf16_f32 v221, v222, v223
    ds_write_b64 v247, v[220:221] offset:8192
    ds_read_b128 v[36:39], v248 offset:8192
    ds_read_b64 v[40:41], v248 offset:9224
    ds_read_b64 v[42:43], v248 offset:9216
    s_mov_b32 s54, 16384
    s_mov_b32 s55, 18432
    s_waitcnt lgkmcnt(0)
    buffer_store_dwordx4 v[36:39], v249, s[16:19], s54 offen sc1 nt
    buffer_store_dwordx4 v[40:43], v249, s[16:19], s55 offen sc1 nt
    s_endpgm

.section .rodata,"a"
.p2align 6
.amdhsa_kernel standalone__gqa_softmax__near_ridge_kernel
  .amdhsa_next_free_vgpr 512
  .amdhsa_next_free_sgpr 102
  .amdhsa_accum_offset 256
  .amdhsa_group_segment_fixed_size 0
  .amdhsa_kernarg_size 48
  .amdhsa_user_sgpr_count 2
  .amdhsa_user_sgpr_kernarg_segment_ptr 1
  .amdhsa_system_sgpr_workgroup_id_x 1
.end_amdhsa_kernel
```
